```python
import torch

def _softmax(x, axis=-1):
    return torch.softmax(x, dim=axis)
def _gelu(x):
    return torch.nn.functional.gelu(x, approximate="tanh")
def _silu(x):
    return torch.nn.functional.silu(x)
def _sigmoid(x):
    return torch.sigmoid(x)
def _layernorm(x, axis=-1, eps=1e-5):
    m = x.mean(dim=axis, keepdim=True)
    v = x.var(dim=axis, keepdim=True, unbiased=False)
    return (x - m) / torch.sqrt(v + eps)
def _scatter_add(tgt, idx, src, axis=0):
    return tgt.clone().index_add_(axis, idx, src)
def _segment_sum(src, seg, n):
    out = torch.zeros((n,) + src.shape[1:], dtype=src.dtype)
    return out.index_add_(0, seg, src)
def _pad(x, pw):
    flat = tuple(v for pair in reversed(pw) for v in pair)
    return torch.nn.functional.pad(x, flat)

kernel_name = 'gated_mix__linear_attn_block__mixer_token_mlp__prompt'

def setup_inputs():

    _w = (lambda a: (lambda t: t.to(torch.bfloat16) if t.is_floating_point() else t)(torch.as_tensor(a)))
    def _A_setup():
        B, S, D = 1, 2048, 512
        return {
            "x": _w((lambda *s: torch.randn(*s, dtype=torch.bfloat16) * 0.05)(B, S, D)),
            "wqkv": _w((lambda *s: torch.randn(*s, dtype=torch.bfloat16) * 0.4)(D, 3 * D)),
            "wo": _w((lambda *s: torch.randn(*s, dtype=torch.bfloat16) * 0.05)(D, D)),
        }
    _A_in = _A_setup()

    def _B_setup():
        B, S, D, F = 1, 2048, 512, 1376
        return {
            "x": _w((lambda *s: torch.randn(*s, dtype=torch.bfloat16) * 0.05)(B, S, D)),
            "w1": _w((lambda *s: torch.randn(*s, dtype=torch.bfloat16) * 0.4)(S, F) * (S ** -0.5)),
            "b1": _w((lambda *s: torch.randn(*s, dtype=torch.bfloat16) * 3.2)(F) * 0.02),
            "w2": _w((lambda *s: torch.randn(*s, dtype=torch.bfloat16) * 0.05)(F, S) * (F ** -0.5)),
            "b2": _w((lambda *s: torch.randn(*s, dtype=torch.bfloat16) * 0.1)(S) * 0.02),
        }
    _B_in = _B_setup()

    return {
        "A_x": _A_in["x"],
        "A_wqkv": _A_in["wqkv"],
        "A_wo": _A_in["wo"],
        "B_x": _B_in["x"],
        "B_w1": _B_in["w1"],
        "B_b1": _B_in["b1"],
        "B_w2": _B_in["w2"],
        "B_b2": _B_in["b2"],
        "gate_w": _w((lambda *s: torch.randn(*s, dtype=torch.bfloat16) * 0.05)(512) * 16.0),
    }

def reference(A_x, A_wqkv, A_wo, B_x, B_w1, B_b1, B_w2, B_b2, gate_w):
    def _A_ref(x, wqkv, wo):
        B, S, D = x.shape
        H = 32; Dh = D // H
        qkv = (lambda x, *d: x.permute(*d))((x @ wqkv).reshape(B, S, 3, H, Dh), 2, 0, 3, 1, 4)
        q, k, v = qkv[0], qkv[1], qkv[2]
        phi = lambda t: torch.where(t > 0, t + 1, torch.exp(t)) + 1e-6
        pq, pk = phi(q), phi(k)
        kv = torch.einsum("bhsd,bhse->bhde", pk, v)
        z = torch.einsum("bhsd->bhd", pk)
        num = torch.einsum("bhqd,bhde->bhqe", pq, kv)
        den = torch.einsum("bhqd,bhd->bhq", pq, z)[..., None] + 1e-6
        o = num / den
        return (lambda x, *d: x.permute(*d))(o, 0, 2, 1, 3).reshape(B, S, D) @ wo

    def _B_ref(x, w1, b1, w2, b2):
        B, S, D = x.shape
        h = _layernorm(x, axis=-1)
        u = torch.einsum("bsd,sf->bdf", h, w1) + b1
        u = _gelu(u)
        y = torch.einsum("bdf,fs->bds", u, w2) + b2
        return (lambda x, *d: x.permute(*d))(y, 0, 2, 1)

    x = A_x
    g = _sigmoid((x * gate_w).sum(-1, keepdims=True))
    a = _A_ref(x, A_wqkv, A_wo)
    b = _B_ref(x, B_w1, B_b1, B_w2, B_b2)
    return g * a + (1 - g) * b
```

```asm
; @launch grid=(256,1,1) block=(256,1,1) lds=163840
.amdgcn_target "amdgcn-amd-amdhsa--gfx950"
.text
.globl gated_mix__linear_attn_block__mixer_token_mlp__prompt_kernel
.p2align 8
.type gated_mix__linear_attn_block__mixer_token_mlp__prompt_kernel,@function
gated_mix__linear_attn_block__mixer_token_mlp__prompt_kernel:
L_code0:
    s_cmp_ge_u32 s2, 256
    s_cbranch_scc1 L_end
    s_load_dwordx16 s[16:31], s[0:1], 0
    s_load_dwordx8 s[32:39], s[0:1], 64
    s_getpc_b64 s[92:93]
L_pc:
    s_lshr_b32 s12, s2, 3
    s_mul_i32 s12, s12, 1536
    s_sub_u32 s92, s92, L_pc-L_code0
    s_subb_u32 s93, s93, 0
    v_lshl_add_u32 v30, v0, 7, s12
    v_min_u32 v30, L_end-L_code0, v30
    v_mov_b32 v31, s93
    v_cmp_gt_u32 s[94:95], 12, v0
    v_add_co_u32 v30, vcc, s92, v30
    s_nop 1
    v_addc_co_u32 v31, vcc, 0, v31, vcc
    s_mov_b64 exec, s[94:95]
    s_cbranch_execz L_cs_1
    global_load_dword v157, v[30:31], off
L_cs_1:
    s_mov_b64 exec, -1
    v_lshrrev_b32 v2, 6, v0
    v_and_b32 v1, 63, v0
    v_readfirstlane_b32 s3, v2
    s_and_b32 s4, s2, 7
    s_lshr_b32 s6, s2, 3
    s_and_b32 s5, s4, 1
    s_lshr_b32 s4, s4, 1
    s_bfe_u32 s8, s6, 0x20002
    s_lshl_b32 s12, s4, 2
    s_add_u32 s8, s8, s12
    s_and_b32 s9, s6, 3
    s_lshl_b32 s12, s5, 2
    s_add_u32 s9, s9, s12
    s_and_b32 s10, s6, 3
    s_and_b32 s12, s2, 7
    s_lshl_b32 s12, s12, 2
    s_add_u32 s10, s10, s12
    s_lshr_b32 s11, s6, 4
    s_xor_b32 s11, s11, s6
    s_and_b32 s11, s11, 1
    s_lshr_b32 s12, s6, 1
    s_and_b32 s12, s12, 6
    s_add_u32 s11, s11, s12
    s_mul_i32 s7, s3, 40960
    v_and_b32 v2, 15, v1
    v_lshrrev_b32 v3, 4, v1
    v_lshlrev_b32 v4, 4, v1
    v_mov_b32 v5, 0
    s_cmp_lt_u32 s6, 16
    s_cbranch_scc1 L_qrole
    s_and_b32 s12, s2, 0xf7
    s_cmp_lg_u32 s12, 230
    s_cbranch_scc1 L_urole
    v_mov_b32 v31, 1
    v_lshlrev_b32 v30, 8, v0
    s_waitcnt lgkmcnt(0)
    s_mov_b32 s80, s38
    s_mov_b32 s81, s39
    s_mov_b32 s82, 12582912
    s_mov_b32 s83, 0x20000
    s_mov_b32 s76, s36
    s_mov_b32 s77, s37
    s_mov_b32 s78, 256
    s_mov_b32 s79, 0x20000
    s_cmp_lg_u32 s2, 230
    s_cbranch_scc1 L_n1_3
    s_cmp_lg_u32 s3, 0
    s_cbranch_scc1 L_nz_2
    s_mov_b32 s12, 6971392
    s_mov_b64 exec, 0xffffffff
    buffer_store_dword v5, v30, s[80:83], s12 offen sc1
    s_mov_b64 exec, -1
    s_waitcnt vmcnt(0)
    buffer_store_dword v31, v5, s[76:79], 0 offen sc1
    s_branch L_nz_2
L_n1_3:
    v_lshrrev_b32 v29, 5, v0
    v_cmp_ne_u32 vcc, 3, v29
    s_mov_b32 s12, 6946816
    s_and_b64 exec, exec, vcc
    buffer_store_dword v5, v30, s[80:83], s12 offen sc1
    s_mov_b64 exec, -1
    v_lshlrev_b32 v30, 6, v0
    s_mov_b32 s12, 7012352
    buffer_store_dword v5, v30, s[80:83], s12 offen sc1
    s_mov_b32 s12, 7028736
    buffer_store_dword v5, v30, s[80:83], s12 offen sc1
    v_mov_b32 v32, 0
    v_mov_b32 v33, 0
    v_mov_b32 v34, 0
    v_mov_b32 v35, 0
    v_lshlrev_b32 v30, 4, v0
    s_mov_b32 s12, 6291456
    buffer_store_dwordx4 v[32:35], v30, s[80:83], s12 offen sc1
    s_mov_b32 s12, 6295552
    buffer_store_dwordx4 v[32:35], v30, s[80:83], s12 offen sc1
    s_mov_b32 s12, 6299648
    buffer_store_dwordx4 v[32:35], v30, s[80:83], s12 offen sc1
    s_mov_b32 s12, 6303744
    buffer_store_dwordx4 v[32:35], v30, s[80:83], s12 offen sc1
    s_mov_b32 s12, 6307840
    buffer_store_dwordx4 v[32:35], v30, s[80:83], s12 offen sc1
    s_mov_b32 s12, 6311936
    buffer_store_dwordx4 v[32:35], v30, s[80:83], s12 offen sc1
    s_mov_b32 s12, 6316032
    buffer_store_dwordx4 v[32:35], v30, s[80:83], s12 offen sc1
    s_mov_b32 s12, 6320128
    buffer_store_dwordx4 v[32:35], v30, s[80:83], s12 offen sc1
    s_mov_b32 s12, 6324224
    buffer_store_dwordx4 v[32:35], v30, s[80:83], s12 offen sc1
    s_waitcnt vmcnt(0)
    s_barrier
    s_cmp_lg_u32 s3, 0
    s_cbranch_scc1 L_nz_2
    buffer_store_dword v31, v5, s[76:79], 0 offen offset:128 sc1
L_nz_2:
    s_branch L_urole
L_qrole:
    s_lshl_b32 s15, s8, 7
    s_lshl_b32 s12, s9, 4
    s_add_u32 s15, s15, s12
    s_lshl_b32 s12, s3, 2
    s_add_u32 s12, s12, s15
    s_lshl_b32 s12, s12, 10
    v_lshlrev_b32 v7, 4, v2
    v_lshl_add_u32 v6, v3, 10, v7
    s_waitcnt lgkmcnt(0)
    s_mov_b32 s40, s16
    s_mov_b32 s41, s17
    s_mov_b32 s42, 2097152
    s_mov_b32 s43, 0x20000
    buffer_load_dwordx4 v[32:35], v6, s[40:43], s12 offen offset:0
    buffer_load_dwordx4 v[36:39], v6, s[40:43], s12 offen offset:256
    buffer_load_dwordx4 v[40:43], v6, s[40:43], s12 offen offset:512
    buffer_load_dwordx4 v[44:47], v6, s[40:43], s12 offen offset:768
    s_mov_b32 s68, s32
    s_mov_b32 s69, s33
    s_mov_b32 s70, 1024
    s_mov_b32 s71, 0x20000
    buffer_load_dwordx4 v[48:51], v7, s[68:71], 0 offen offset:0
    buffer_load_dwordx4 v[52:55], v7, s[68:71], 0 offen offset:256
    buffer_load_dwordx4 v[56:59], v7, s[68:71], 0 offen offset:512
    buffer_load_dwordx4 v[60:63], v7, s[68:71], 0 offen offset:768
    s_mov_b32 s44, s18
    s_mov_b32 s45, s19
    s_mov_b32 s46, 1572864
    s_mov_b32 s47, 0x20000
    s_lshl_b32 s12, s6, 2
    s_add_u32 s12, s12, s3
    v_lshrrev_b32 v116, 3, v1
    v_mul_u32_u24 v116, 3072, v116
    v_bfe_u32 v117, v1, 2, 1
    v_lshl_add_u32 v116, v117, 10, v116
    v_and_b32 v117, 3, v1
    v_lshl_add_u32 v116, v117, 7, v116
    s_mul_i32 s13, s12, 12288
    s_lshl_b32 s14, s5, 9
    s_add_u32 s13, s13, s14
    s_mov_b64 exec, 0xffffffff
    buffer_load_dword v157, v116, s[44:47], s13 offen offset:1024
    s_mov_b64 exec, -1
    s_mov_b32 s80, s38
    s_mov_b32 s81, s39
    s_mov_b32 s82, 12582912
    s_mov_b32 s83, 0x20000
    s_mov_b32 s76, s36
    s_mov_b32 s77, s37
    s_mov_b32 s78, 256
    s_mov_b32 s79, 0x20000
    s_mov_b32 s48, s20
    s_mov_b32 s49, s21
    s_mov_b32 s50, 524288
    s_mov_b32 s51, 0x20000
    s_mov_b32 s60, s28
    s_mov_b32 s61, s29
    s_mov_b32 s62, 5636096
    s_mov_b32 s63, 0x20000
    s_mov_b32 s64, s30
    s_mov_b32 s65, s31
    s_mov_b32 s66, 4096
    s_mov_b32 s67, 0x20000
    s_mov_b32 s72, s34
    s_mov_b32 s73, s35
    s_mov_b32 s74, 2097152
    s_mov_b32 s75, 0x20000
    v_lshrrev_b32 v12, 3, v1
    v_and_b32 v13, 7, v1
    v_lshrrev_b32 v14, 1, v12
    v_xor_b32 v14, v14, v13
    v_lshlrev_b32 v14, 4, v14
    v_lshl_add_u32 v14, v12, 10, v14
    v_xor_b32 v15, 64, v14
    s_lshl_b32 s13, s8, 17
    s_lshl_b32 s12, s3, 15
    s_add_u32 s13, s13, s12
    v_add_u32 v144, s13, v14
    s_add_u32 s13, s13, 7168
    v_add_u32 v145, s13, v15
    v_add_u32 v146, 14336, v144
    v_add_u32 v147, 14336, v145
    v_and_b32 v16, 2, v12
    v_xor_b32 v16, v16, v13
    v_lshlrev_b32 v16, 4, v16
    v_xor_b32 v17, 64, v16
    v_mul_u32_u24 v12, 3072, v12
    s_mul_i32 s13, s3, 49152
    s_lshl_b32 s12, s9, 7
    s_add_u32 s13, s13, s12
    v_add3_u32 v148, v16, v12, s13
    s_add_u32 s13, s13, 23552
    v_add3_u32 v149, v17, v12, s13
    v_add_u32 v150, 1024, v148
    v_add_u32 v151, 1024, v149
    v_add_u32 v152, 2048, v148
    v_add_u32 v153, 2048, v149
    s_lshl_b32 s90, s3, 12
    s_lshl_b32 s91, s3, 11
    s_mul_i32 s12, s3, 4352
    s_add_u32 s12, s12, 146432
    v_mul_u32_u24 v8, 1088, v3
    v_add3_u32 v8, v8, v7, s12
    v_and_b32 v9, 1, v3
    v_lshlrev_b32 v9, 3, v9
    v_lshrrev_b32 v10, 2, v2
    v_add_u32 v9, v9, v10
    v_mul_u32_u24 v9, 1088, v9
    v_lshrrev_b32 v10, 1, v3
    v_lshl_add_u32 v9, v10, 5, v9
    v_and_b32 v11, 3, v2
    v_lshl_add_u32 v9, v11, 3, v9
    s_lshl_b32 s12, s3, 8
    s_add_u32 s12, s12, 146432
    v_add_u32 v9, s12, v9
    v_mul_u32_u24 v10, 65536, v10
    v_and_b32 v11, 1, v3
    v_lshl_add_u32 v10, v11, 8, v10
    v_add_u32 v10, v10, v7
    s_mul_i32 s84, s3, 524288
    s_lshl_b32 s12, s15, 5
    s_add_u32 s84, s84, s12
    s_lshl_b32 s12, s3, 2
    s_add_u32 s12, s12, s15
    s_lshl_b32 s12, s12, 2
    s_add_u32 s12, s12, 6881280
    v_lshl_add_u32 v11, v3, 2, s12
    v_cmp_eq_u32 vcc, 0, v2
    v_mov_b32 v12, 0x7ffffff0
    s_mov_b32 s85, 0x3f803f80
    v_cndmask_b32 v11, v12, v11, vcc
    s_lshr_b32 s96, s3, 1
    s_and_b32 s97, s3, 1
    v_lshrrev_b32 v18, 1, v2
    v_xor_b32 v18, v18, v3
    v_lshlrev_b32 v18, 4, v18
    v_lshl_add_u32 v18, v2, 7, v18
    s_lshl_b32 s12, s96, 13
    v_add_u32 v18, s12, v18
    v_xor_b32 v19, 64, v18
    v_add_u32 v20, 65536, v18
    v_add_u32 v21, 65536, v19
    v_lshrrev_b32 v22, 2, v2
    v_lshrrev_b32 v23, 3, v2
    v_and_b32 v24, 1, v3
    v_lshl_add_u32 v23, v24, 1, v23
    s_lshl_b32 s12, s97, 1
    v_xor_b32 v23, s12, v23
    v_lshl_add_u32 v22, v3, 3, v22
    v_lshlrev_b32 v22, 7, v22
    v_lshl_add_u32 v22, v23, 5, v22
    v_and_b32 v24, 3, v2
    v_lshl_add_u32 v22, v24, 3, v22
    v_add_u32 v22, 16384, v22
    v_add_u32 v14, 81920, v22
    v_xor_b32 v15, 32, v14
    s_lshl_b32 s12, s96, 5
    v_xor_b32 v23, s12, v22
    v_xor_b32 v22, 32, v23
    v_add_u32 v24, 65536, v22
    v_add_u32 v25, 65536, v23
    v_lshrrev_b32 v154, 2, v1
    v_and_b32 v155, 3, v1
    v_lshlrev_b32 v154, 12, v154
    v_lshl_add_u32 v154, v155, 7, v154
    s_mul_i32 s13, s3, 1441792
    s_lshl_b32 s14, s6, 16
    s_add_u32 s13, s13, s14
    s_and_b32 s14, s2, 7
    s_lshl_b32 s14, s14, 9
    s_add_u32 s13, s13, s14
    v_add_u32 v154, s13, v154
    s_waitcnt vmcnt(5)
    v_dot2_f32_bf16 v26, v32, s85, 0
    s_add_u32 m0, s90, 0
    v_dot2_f32_bf16 v27, v33, s85, 0
    v_dot2_f32_bf16 v26, v34, s85, v26
    v_dot2_f32_bf16 v27, v35, s85, v27
    v_dot2_f32_bf16 v26, v36, s85, v26
    v_dot2_f32_bf16 v27, v37, s85, v27
    v_dot2_f32_bf16 v26, v38, s85, v26
    v_dot2_f32_bf16 v27, v39, s85, v27
    v_dot2_f32_bf16 v26, v40, s85, v26
    v_dot2_f32_bf16 v27, v41, s85, v27
    v_dot2_f32_bf16 v26, v42, s85, v26
    s_mov_b32 s88, 0
    v_dot2_f32_bf16 v27, v43, s85, v27
    v_dot2_f32_bf16 v26, v44, s85, v26
    v_dot2_f32_bf16 v27, v45, s85, v27
    v_dot2_f32_bf16 v26, v46, s85, v26
    v_dot2_f32_bf16 v27, v47, s85, v27
    v_lshlrev_b32 v64, 16, v32
    v_and_b32 v65, 0xffff0000, v32
    v_lshlrev_b32 v66, 16, v33
    v_and_b32 v67, 0xffff0000, v33
    v_add_f32 v26, v26, v27
    v_lshlrev_b32 v68, 16, v34
    buffer_load_dwordx4 v144, s[40:43], s88 offen offset:0 lds
    v_and_b32 v69, 0xffff0000, v34
    v_lshlrev_b32 v70, 16, v35
    v_add_f32_dpp v26, v26, v26 row_ror:8 row_mask:0xf bank_mask:0xf
    v_and_b32 v71, 0xffff0000, v35
    v_lshlrev_b32 v72, 16, v36
    v_and_b32 v73, 0xffff0000, v36
    v_add_f32_dpp v26, v26, v26 row_ror:4 row_mask:0xf bank_mask:0xf
    v_lshlrev_b32 v74, 16, v37
    v_and_b32 v75, 0xffff0000, v37
    v_lshlrev_b32 v76, 16, v38
    buffer_load_dwordx4 v145, s[40:43], s88 offen offset:1024 lds
    v_add_f32_dpp v26, v26, v26 row_ror:2 row_mask:0xf bank_mask:0xf
    v_and_b32 v77, 0xffff0000, v38
    v_lshlrev_b32 v78, 16, v39
    v_and_b32 v79, 0xffff0000, v39
    v_add_f32_dpp v26, v26, v26 row_ror:1 row_mask:0xf bank_mask:0xf
    v_lshlrev_b32 v80, 16, v40
    v_and_b32 v81, 0xffff0000, v40
    v_lshlrev_b32 v82, 16, v41
    v_and_b32 v83, 0xffff0000, v41
    v_lshlrev_b32 v84, 16, v42
    v_and_b32 v85, 0xffff0000, v42
    buffer_load_dwordx4 v146, s[40:43], s88 offen offset:2048 lds
    v_lshlrev_b32 v86, 16, v43
    v_and_b32 v87, 0xffff0000, v43
    v_lshlrev_b32 v88, 16, v44
    v_and_b32 v89, 0xffff0000, v44
    v_lshlrev_b32 v90, 16, v45
    v_and_b32 v91, 0xffff0000, v45
    v_lshlrev_b32 v92, 16, v46
    v_and_b32 v93, 0xffff0000, v46
    v_lshlrev_b32 v94, 16, v47
    v_and_b32 v95, 0xffff0000, v47
    buffer_load_dwordx4 v147, s[40:43], s88 offen offset:3072 lds
    v_mul_f32 v26, 0xbb000000, v26
    v_pk_add_f32 v[64:65], v[64:65], v[26:27] op_sel_hi:[1,0]
    v_pk_add_f32 v[66:67], v[66:67], v[26:27] op_sel_hi:[1,0]
    v_pk_add_f32 v[68:69], v[68:69], v[26:27] op_sel_hi:[1,0]
    v_pk_add_f32 v[70:71], v[70:71], v[26:27] op_sel_hi:[1,0]
    v_pk_add_f32 v[72:73], v[72:73], v[26:27] op_sel_hi:[1,0]
    v_pk_add_f32 v[74:75], v[74:75], v[26:27] op_sel_hi:[1,0]
    v_pk_add_f32 v[76:77], v[76:77], v[26:27] op_sel_hi:[1,0]
    v_pk_add_f32 v[78:79], v[78:79], v[26:27] op_sel_hi:[1,0]
    v_pk_add_f32 v[80:81], v[80:81], v[26:27] op_sel_hi:[1,0]
    v_pk_add_f32 v[82:83], v[82:83], v[26:27] op_sel_hi:[1,0]
    s_add_u32 m0, s91, 16384
    v_pk_add_f32 v[84:85], v[84:85], v[26:27] op_sel_hi:[1,0]
    v_pk_add_f32 v[86:87], v[86:87], v[26:27] op_sel_hi:[1,0]
    v_pk_add_f32 v[88:89], v[88:89], v[26:27] op_sel_hi:[1,0]
    v_pk_add_f32 v[90:91], v[90:91], v[26:27] op_sel_hi:[1,0]
    v_pk_add_f32 v[92:93], v[92:93], v[26:27] op_sel_hi:[1,0]
    v_pk_add_f32 v[94:95], v[94:95], v[26:27] op_sel_hi:[1,0]
    v_pk_mul_f32 v[96:97], v[64:65], v[64:65]
    v_pk_mul_f32 v[98:99], v[66:67], v[66:67]
    v_pk_fma_f32 v[96:97], v[68:69], v[68:69], v[96:97]
    v_pk_fma_f32 v[98:99], v[70:71], v[70:71], v[98:99]
    v_pk_fma_f32 v[96:97], v[72:73], v[72:73], v[96:97]
    s_mov_b32 s89, 0
    v_pk_fma_f32 v[98:99], v[74:75], v[74:75], v[98:99]
    v_pk_fma_f32 v[96:97], v[76:77], v[76:77], v[96:97]
    v_pk_fma_f32 v[98:99], v[78:79], v[78:79], v[98:99]
    v_pk_fma_f32 v[96:97], v[80:81], v[80:81], v[96:97]
    v_pk_fma_f32 v[98:99], v[82:83], v[82:83], v[98:99]
    v_pk_fma_f32 v[96:97], v[84:85], v[84:85], v[96:97]
    v_pk_fma_f32 v[98:99], v[86:87], v[86:87], v[98:99]
    v_pk_fma_f32 v[96:97], v[88:89], v[88:89], v[96:97]
    v_pk_fma_f32 v[98:99], v[90:91], v[90:91], v[98:99]
    v_pk_fma_f32 v[96:97], v[92:93], v[92:93], v[96:97]
    buffer_load_dwordx4 v150, s[44:47], s89 offen offset:0 lds
    v_pk_fma_f32 v[98:99], v[94:95], v[94:95], v[98:99]
    v_pk_add_f32 v[96:97], v[96:97], v[98:99]
    v_add_f32 v26, v96, v97
    s_waitcnt vmcnt(6)
    v_dot2_f32_bf16 v28, v32, v48, 0
    v_dot2_f32_bf16 v29, v33, v49, 0
    v_add_f32_dpp v26, v26, v26 row_ror:8 row_mask:0xf bank_mask:0xf
    v_dot2_f32_bf16 v28, v34, v50, v28
    v_dot2_f32_bf16 v29, v35, v51, v29
    v_add_f32_dpp v26, v26, v26 row_ror:4 row_mask:0xf bank_mask:0xf
    v_dot2_f32_bf16 v28, v36, v52, v28
    buffer_load_dwordx4 v151, s[44:47], s89 offen offset:1024 lds
    v_dot2_f32_bf16 v29, v37, v53, v29
    v_add_f32_dpp v26, v26, v26 row_ror:2 row_mask:0xf bank_mask:0xf
    v_dot2_f32_bf16 v28, v38, v54, v28
    v_dot2_f32_bf16 v29, v39, v55, v29
    v_add_f32_dpp v26, v26, v26 row_ror:1 row_mask:0xf bank_mask:0xf
    v_mov_b32 v27, 0x3727c5ac
    v_fmac_f32 v27, 0x3b000000, v26
    v_rsq_f32 v26, v27
    v_dot2_f32_bf16 v28, v40, v56, v28
    v_pk_mul_f32 v[64:65], v[64:65], v[26:27] op_sel_hi:[1,0]
    s_add_u32 m0, s91, 24576
    v_pk_mul_f32 v[66:67], v[66:67], v[26:27] op_sel_hi:[1,0]
    v_pk_mul_f32 v[68:69], v[68:69], v[26:27] op_sel_hi:[1,0]
    v_pk_mul_f32 v[70:71], v[70:71], v[26:27] op_sel_hi:[1,0]
    v_pk_mul_f32 v[72:73], v[72:73], v[26:27] op_sel_hi:[1,0]
    v_pk_mul_f32 v[74:75], v[74:75], v[26:27] op_sel_hi:[1,0]
    v_pk_mul_f32 v[76:77], v[76:77], v[26:27] op_sel_hi:[1,0]
    v_pk_mul_f32 v[78:79], v[78:79], v[26:27] op_sel_hi:[1,0]
    v_pk_mul_f32 v[80:81], v[80:81], v[26:27] op_sel_hi:[1,0]
    v_pk_mul_f32 v[82:83], v[82:83], v[26:27] op_sel_hi:[1,0]
    v_pk_mul_f32 v[84:85], v[84:85], v[26:27] op_sel_hi:[1,0]
    v_pk_mul_f32 v[86:87], v[86:87], v[26:27] op_sel_hi:[1,0]
    buffer_load_dwordx4 v152, s[44:47], s89 offen offset:0 lds
    v_pk_mul_f32 v[88:89], v[88:89], v[26:27] op_sel_hi:[1,0]
    v_pk_mul_f32 v[90:91], v[90:91], v[26:27] op_sel_hi:[1,0]
    v_pk_mul_f32 v[92:93], v[92:93], v[26:27] op_sel_hi:[1,0]
    v_pk_mul_f32 v[94:95], v[94:95], v[26:27] op_sel_hi:[1,0]
    v_cvt_pk_bf16_f32 v100, v64, v65
    v_cvt_pk_bf16_f32 v101, v66, v67
    v_cvt_pk_bf16_f32 v102, v68, v69
    v_cvt_pk_bf16_f32 v103, v70, v71
    ds_write_b128 v8, v[100:103] offset:0
    v_cvt_pk_bf16_f32 v104, v72, v73
    buffer_load_dwordx4 v153, s[44:47], s89 offen offset:1024 lds
    v_cvt_pk_bf16_f32 v105, v74, v75
    v_cvt_pk_bf16_f32 v106, v76, v77
    v_cvt_pk_bf16_f32 v107, v78, v79
    ds_write_b128 v8, v[104:107] offset:256
    v_cvt_pk_bf16_f32 v108, v80, v81
    v_cvt_pk_bf16_f32 v109, v82, v83
    v_cvt_pk_bf16_f32 v110, v84, v85
    v_cvt_pk_bf16_f32 v111, v86, v87
    ds_write_b128 v8, v[108:111] offset:512
    v_cvt_pk_bf16_f32 v112, v88, v89
    v_cvt_pk_bf16_f32 v113, v90, v91
    v_cvt_pk_bf16_f32 v114, v92, v93
    v_cvt_pk_bf16_f32 v115, v94, v95
    ds_write_b128 v8, v[112:115] offset:768
    v_dot2_f32_bf16 v29, v41, v57, v29
    v_dot2_f32_bf16 v28, v42, v58, v28
    v_dot2_f32_bf16 v29, v43, v59, v29
    v_dot2_f32_bf16 v28, v44, v60, v28
    v_dot2_f32_bf16 v29, v45, v61, v29
    v_dot2_f32_bf16 v28, v46, v62, v28
    v_dot2_f32_bf16 v29, v47, v63, v29
    s_waitcnt lgkmcnt(0)
    s_barrier
    ds_read_b64_tr_b16 v[64:65], v9 offset:0
    ds_read_b64_tr_b16 v[66:67], v9 offset:4352
    ds_read_b64_tr_b16 v[68:69], v9 offset:64
    ds_read_b64_tr_b16 v[70:71], v9 offset:4416
    ds_read_b64_tr_b16 v[72:73], v9 offset:128
    ds_read_b64_tr_b16 v[74:75], v9 offset:4480
    ds_read_b64_tr_b16 v[76:77], v9 offset:192
    ds_read_b64_tr_b16 v[78:79], v9 offset:4544
    v_add_f32 v28, v28, v29
    s_waitcnt lgkmcnt(6)
    s_add_u32 s12, s84, 0
    buffer_store_dwordx4 v[64:67], v10, s[80:83], s12 offen sc1
    s_waitcnt lgkmcnt(4)
    s_add_u32 s12, s84, 131072
    buffer_store_dwordx4 v[68:71], v10, s[80:83], s12 offen sc1
    s_waitcnt lgkmcnt(2)
    s_add_u32 s12, s84, 262144
    buffer_store_dwordx4 v[72:75], v10, s[80:83], s12 offen sc1
    s_waitcnt lgkmcnt(0)
    s_add_u32 s12, s84, 393216
    buffer_store_dwordx4 v[76:79], v10, s[80:83], s12 offen sc1
    v_add_f32_dpp v28, v28, v28 row_ror:8 row_mask:0xf bank_mask:0xf
    s_nop 1
    v_add_f32_dpp v28, v28, v28 row_ror:4 row_mask:0xf bank_mask:0xf
    s_nop 1
    v_add_f32_dpp v28, v28, v28 row_ror:2 row_mask:0xf bank_mask:0xf
    s_nop 1
    v_add_f32_dpp v28, v28, v28 row_ror:1 row_mask:0xf bank_mask:0xf
    s_nop 1
    v_mul_f32 v28, 0xbfb8aa3b, v28
    v_exp_f32 v28, v28
    s_nop 0
    v_add_f32 v28, 1.0, v28
    v_rcp_f32 v28, v28
    s_nop 0
    buffer_store_dword v28, v11, s[80:83], 0 offen sc1
    buffer_load_dword v31, v5, s[76:79], 0 offen sc1
    s_add_u32 m0, s90, 32768
    s_mov_b32 s88, 128
    buffer_load_dwordx4 v144, s[40:43], s88 offen offset:0 lds
    buffer_load_dwordx4 v145, s[40:43], s88 offen offset:1024 lds
    buffer_load_dwordx4 v146, s[40:43], s88 offen offset:2048 lds
    buffer_load_dwordx4 v147, s[40:43], s88 offen offset:3072 lds
    s_add_u32 m0, s91, 49152
    s_mov_b32 s89, 196608
    buffer_load_dwordx4 v150, s[44:47], s89 offen offset:0 lds
    buffer_load_dwordx4 v151, s[44:47], s89 offen offset:1024 lds
    s_add_u32 m0, s91, 57344
    s_nop 0
    buffer_load_dwordx4 v152, s[44:47], s89 offen offset:0 lds
    buffer_load_dwordx4 v153, s[44:47], s89 offen offset:1024 lds
    s_waitcnt vmcnt(14)
    s_barrier
    ds_read_b128 a[0:3], v18 offset:0
    ds_read_b128 a[4:7], v18 offset:2048
    ds_read_b128 a[8:11], v18 offset:4096
    ds_read_b128 a[12:15], v18 offset:6144
    ds_read_b64_tr_b16 v[96:97], v22 offset:0
    ds_read_b64_tr_b16 v[98:99], v22 offset:512
    ds_read_b64_tr_b16 v[100:101], v23 offset:0
    ds_read_b64_tr_b16 v[102:103], v23 offset:512
    ds_read_b64_tr_b16 v[104:105], v22 offset:8192
    ds_read_b64_tr_b16 v[106:107], v22 offset:8704
    ds_read_b64_tr_b16 v[108:109], v23 offset:8192
    ds_read_b64_tr_b16 v[110:111], v23 offset:8704
    s_waitcnt lgkmcnt(0)
    v_mfma_f32_16x16x32_bf16 v[192:195], a[0:3], v[96:99], 0
    ds_read_b128 a[16:19], v19 offset:0
    s_add_u32 m0, s90, 65536
    v_mfma_f32_16x16x32_bf16 v[196:199], a[4:7], v[96:99], 0
    s_mov_b32 s88, 256
    ds_read_b128 a[20:23], v19 offset:2048
    v_mfma_f32_16x16x32_bf16 v[200:203], a[8:11], v[96:99], 0
    buffer_load_dwordx4 v144, s[40:43], s88 offen offset:0 lds
    ds_read_b128 a[24:27], v19 offset:4096
    v_mfma_f32_16x16x32_bf16 v[204:207], a[12:15], v[96:99], 0
    buffer_load_dwordx4 v145, s[40:43], s88 offen offset:1024 lds
    ds_read_b128 a[28:31], v19 offset:6144
    v_mfma_f32_16x16x32_bf16 v[208:211], a[0:3], v[100:103], 0
    buffer_load_dwordx4 v146, s[40:43], s88 offen offset:2048 lds
    ds_read_b64_tr_b16 v[112:113], v22 offset:4096
    v_mfma_f32_16x16x32_bf16 v[212:215], a[4:7], v[100:103], 0
    buffer_load_dwordx4 v147, s[40:43], s88 offen offset:3072 lds
    ds_read_b64_tr_b16 v[114:115], v22 offset:4608
    v_mfma_f32_16x16x32_bf16 v[216:219], a[8:11], v[100:103], 0
    s_add_u32 m0, s91, 81920
    ds_read_b64_tr_b16 v[116:117], v23 offset:4096
    v_mfma_f32_16x16x32_bf16 v[220:223], a[12:15], v[100:103], 0
    s_mov_b32 s89, 393216
    ds_read_b64_tr_b16 v[118:119], v23 offset:4608
    v_mfma_f32_16x16x32_bf16 v[224:227], a[0:3], v[104:107], 0
    buffer_load_dwordx4 v150, s[44:47], s89 offen offset:0 lds
    ds_read_b64_tr_b16 v[120:121], v22 offset:12288
    v_mfma_f32_16x16x32_bf16 v[228:231], a[4:7], v[104:107], 0
    buffer_load_dwordx4 v151, s[44:47], s89 offen offset:1024 lds
    ds_read_b64_tr_b16 v[122:123], v22 offset:12800
    v_mfma_f32_16x16x32_bf16 v[232:235], a[8:11], v[104:107], 0
    s_add_u32 m0, s91, 90112
    ds_read_b64_tr_b16 v[124:125], v23 offset:12288
    v_mfma_f32_16x16x32_bf16 v[236:239], a[12:15], v[104:107], 0
    buffer_load_dwordx4 v152, s[44:47], s89 offen offset:0 lds
    ds_read_b64_tr_b16 v[126:127], v23 offset:12800
    v_mfma_f32_16x16x32_bf16 v[240:243], a[0:3], v[108:111], 0
    buffer_load_dwordx4 v153, s[44:47], s89 offen offset:1024 lds
    v_mfma_f32_16x16x32_bf16 v[244:247], a[4:7], v[108:111], 0
    v_mfma_f32_16x16x32_bf16 v[248:251], a[8:11], v[108:111], 0
    v_mfma_f32_16x16x32_bf16 v[252:255], a[12:15], v[108:111], 0
    s_waitcnt lgkmcnt(0)
    v_mfma_f32_16x16x32_bf16 v[192:195], a[16:19], v[112:115], v[192:195]
    s_waitcnt vmcnt(8)
    v_cmp_gt_u32 vcc, 1, v31
    s_cbranch_vccz L_z_4
    s_mov_b32 s14, 0
L_poll_5:
    buffer_load_dword v31, v5, s[76:79], 0 offen sc1
    s_add_u32 s14, s14, 1
    s_waitcnt vmcnt(0)
    v_cmp_gt_u32 vcc, 1, v31
    s_cbranch_vccz L_polled_6
    s_sleep 1
    s_cmp_lt_u32 s14, 0x40000
    s_cbranch_scc1 L_poll_5
L_polled_6:
L_z_4:
    s_barrier
    v_mfma_f32_16x16x32_bf16 v[196:199], a[20:23], v[112:115], v[196:199]
    s_lshr_b32 s12, s8, 2
    s_lshl_b32 s12, s12, 11
    s_add_u32 s12, s12, 6971392
    s_cmp_lg_u32 s3, 0
    s_cbranch_scc1 L_arr_7
    v_lshlrev_b32 v30, 8, v1
    v_mov_b32 v31, 1
    s_mov_b64 exec, 255
    buffer_atomic_add v31, v30, s[80:83], s12 offen sc1
    s_mov_b64 exec, -1
L_arr_7:
    ds_read_b128 a[32:35], v18 offset:32768
    v_mfma_f32_16x16x32_bf16 v[200:203], a[24:27], v[112:115], v[200:203]
    ds_read_b128 a[36:39], v18 offset:34816
    v_mfma_f32_16x16x32_bf16 v[204:207], a[28:31], v[112:115], v[204:207]
    s_add_u32 m0, s90, 0
    v_mfma_f32_16x16x32_bf16 v[208:211], a[16:19], v[116:119], v[208:211]
    ds_read_b128 a[40:43], v18 offset:36864
    ds_read_b128 a[44:47], v18 offset:38912
    v_mfma_f32_16x16x32_bf16 v[212:215], a[20:23], v[116:119], v[212:215]
    s_mov_b32 s88, 384
    ds_read_b64_tr_b16 v[96:97], v22 offset:32768
    v_mfma_f32_16x16x32_bf16 v[216:219], a[24:27], v[116:119], v[216:219]
    ds_read_b64_tr_b16 v[98:99], v22 offset:33280
    v_mfma_f32_16x16x32_bf16 v[220:223], a[28:31], v[116:119], v[220:223]
    buffer_load_dwordx4 v144, s[40:43], s88 offen offset:0 lds
    ds_read_b64_tr_b16 v[100:101], v23 offset:32768
    v_mfma_f32_16x16x32_bf16 v[224:227], a[16:19], v[120:123], v[224:227]
    buffer_load_dwordx4 v145, s[40:43], s88 offen offset:1024 lds
    ds_read_b64_tr_b16 v[102:103], v23 offset:33280
    v_mfma_f32_16x16x32_bf16 v[228:231], a[20:23], v[120:123], v[228:231]
    ds_read_b64_tr_b16 v[104:105], v22 offset:40960
    v_mfma_f32_16x16x32_bf16 v[232:235], a[24:27], v[120:123], v[232:235]
    buffer_load_dwordx4 v146, s[40:43], s88 offen offset:2048 lds
    ds_read_b64_tr_b16 v[106:107], v22 offset:41472
    v_mfma_f32_16x16x32_bf16 v[236:239], a[28:31], v[120:123], v[236:239]
    ds_read_b64_tr_b16 v[108:109], v23 offset:40960
    buffer_load_dwordx4 v147, s[40:43], s88 offen offset:3072 lds
    v_mfma_f32_16x16x32_bf16 v[240:243], a[16:19], v[124:127], v[240:243]
    ds_read_b64_tr_b16 v[110:111], v23 offset:41472
    v_mfma_f32_16x16x32_bf16 v[244:247], a[20:23], v[124:127], v[244:247]
    v_mfma_f32_16x16x32_bf16 v[248:251], a[24:27], v[124:127], v[248:251]
    v_mfma_f32_16x16x32_bf16 v[252:255], a[28:31], v[124:127], v[252:255]
    s_waitcnt lgkmcnt(0)
    v_mfma_f32_16x16x32_bf16 v[192:195], a[32:35], v[96:99], v[192:195]
    ds_read_b128 a[48:51], v19 offset:32768
    s_add_u32 m0, s91, 16384
    v_mfma_f32_16x16x32_bf16 v[196:199], a[36:39], v[96:99], v[196:199]
    ds_read_b128 a[52:55], v19 offset:34816
    v_mfma_f32_16x16x32_bf16 v[200:203], a[40:43], v[96:99], v[200:203]
    s_mov_b32 s89, 589824
    ds_read_b128 a[56:59], v19 offset:36864
    v_mfma_f32_16x16x32_bf16 v[204:207], a[44:47], v[96:99], v[204:207]
    ds_read_b128 a[60:63], v19 offset:38912
    v_mfma_f32_16x16x32_bf16 v[208:211], a[32:35], v[100:103], v[208:211]
    buffer_load_dwordx4 v150, s[44:47], s89 offen offset:0 lds
    ds_read_b64_tr_b16 v[112:113], v22 offset:36864
    v_mfma_f32_16x16x32_bf16 v[212:215], a[36:39], v[100:103], v[212:215]
    ds_read_b64_tr_b16 v[114:115], v22 offset:37376
    v_mfma_f32_16x16x32_bf16 v[216:219], a[40:43], v[100:103], v[216:219]
    buffer_load_dwordx4 v151, s[44:47], s89 offen offset:1024 lds
    ds_read_b64_tr_b16 v[116:117], v23 offset:36864
    v_mfma_f32_16x16x32_bf16 v[220:223], a[44:47], v[100:103], v[220:223]
    s_add_u32 m0, s91, 24576
    v_mfma_f32_16x16x32_bf16 v[224:227], a[32:35], v[104:107], v[224:227]
    ds_read_b64_tr_b16 v[118:119], v23 offset:37376
    ds_read_b64_tr_b16 v[120:121], v22 offset:45056
    v_mfma_f32_16x16x32_bf16 v[228:231], a[36:39], v[104:107], v[228:231]
    buffer_load_dwordx4 v152, s[44:47], s89 offen offset:0 lds
    v_mfma_f32_16x16x32_bf16 v[232:235], a[40:43], v[104:107], v[232:235]
    ds_read_b64_tr_b16 v[122:123], v22 offset:45568
    ds_read_b64_tr_b16 v[124:125], v23 offset:45056
    v_mfma_f32_16x16x32_bf16 v[236:239], a[44:47], v[104:107], v[236:239]
    buffer_load_dwordx4 v153, s[44:47], s89 offen offset:1024 lds
    v_mfma_f32_16x16x32_bf16 v[240:243], a[32:35], v[108:111], v[240:243]
    ds_read_b64_tr_b16 v[126:127], v23 offset:45568
    v_mfma_f32_16x16x32_bf16 v[244:247], a[36:39], v[108:111], v[244:247]
    v_mfma_f32_16x16x32_bf16 v[248:251], a[40:43], v[108:111], v[248:251]
    v_mfma_f32_16x16x32_bf16 v[252:255], a[44:47], v[108:111], v[252:255]
    s_waitcnt lgkmcnt(0)
    v_mfma_f32_16x16x32_bf16 v[192:195], a[48:51], v[112:115], v[192:195]
    s_waitcnt vmcnt(8)
    s_barrier
    v_mfma_f32_16x16x32_bf16 v[196:199], a[52:55], v[112:115], v[196:199]
    ds_read_b128 a[64:67], v20 offset:0
    v_mfma_f32_16x16x32_bf16 v[200:203], a[56:59], v[112:115], v[200:203]
    ds_read_b128 a[68:71], v20 offset:2048
    v_mfma_f32_16x16x32_bf16 v[204:207], a[60:63], v[112:115], v[204:207]
    s_add_u32 m0, s90, 32768
    ds_read_b128 a[72:75], v20 offset:4096
    v_mfma_f32_16x16x32_bf16 v[208:211], a[48:51], v[116:119], v[208:211]
    ds_read_b128 a[76:79], v20 offset:6144
    s_mov_b32 s88, 512
    v_mfma_f32_16x16x32_bf16 v[212:215], a[52:55], v[116:119], v[212:215]
    ds_read_b64_tr_b16 v[96:97], v24 offset:0
    v_mfma_f32_16x16x32_bf16 v[216:219], a[56:59], v[116:119], v[216:219]
    ds_read_b64_tr_b16 v[98:99], v24 offset:512
    buffer_load_dwordx4 v144, s[40:43], s88 offen offset:0 lds
    v_mfma_f32_16x16x32_bf16 v[220:223], a[60:63], v[116:119], v[220:223]
    ds_read_b64_tr_b16 v[100:101], v25 offset:0
    v_mfma_f32_16x16x32_bf16 v[224:227], a[48:51], v[120:123], v[224:227]
    buffer_load_dwordx4 v145, s[40:43], s88 offen offset:1024 lds
    ds_read_b64_tr_b16 v[102:103], v25 offset:512
    v_mfma_f32_16x16x32_bf16 v[228:231], a[52:55], v[120:123], v[228:231]
    ds_read_b64_tr_b16 v[104:105], v24 offset:8192
    buffer_load_dwordx4 v146, s[40:43], s88 offen offset:2048 lds
    v_mfma_f32_16x16x32_bf16 v[232:235], a[56:59], v[120:123], v[232:235]
    ds_read_b64_tr_b16 v[106:107], v24 offset:8704
    v_mfma_f32_16x16x32_bf16 v[236:239], a[60:63], v[120:123], v[236:239]
    ds_read_b64_tr_b16 v[108:109], v25 offset:8192
    buffer_load_dwordx4 v147, s[40:43], s88 offen offset:3072 lds
    v_mfma_f32_16x16x32_bf16 v[240:243], a[48:51], v[124:127], v[240:243]
    ds_read_b64_tr_b16 v[110:111], v25 offset:8704
    v_mfma_f32_16x16x32_bf16 v[244:247], a[52:55], v[124:127], v[244:247]
    v_mfma_f32_16x16x32_bf16 v[248:251], a[56:59], v[124:127], v[248:251]
    v_mfma_f32_16x16x32_bf16 v[252:255], a[60:63], v[124:127], v[252:255]
    s_waitcnt lgkmcnt(0)
    v_mfma_f32_16x16x32_bf16 v[192:195], a[64:67], v[96:99], v[192:195]
    ds_read_b128 a[80:83], v21 offset:0
    s_add_u32 m0, s91, 49152
    v_mfma_f32_16x16x32_bf16 v[196:199], a[68:71], v[96:99], v[196:199]
    ds_read_b128 a[84:87], v21 offset:2048
    v_mfma_f32_16x16x32_bf16 v[200:203], a[72:75], v[96:99], v[200:203]
    s_mov_b32 s89, 786432
    ds_read_b128 a[88:91], v21 offset:4096
    v_mfma_f32_16x16x32_bf16 v[204:207], a[76:79], v[96:99], v[204:207]
    ds_read_b128 a[92:95], v21 offset:6144
    v_mfma_f32_16x16x32_bf16 v[208:211], a[64:67], v[100:103], v[208:211]
    buffer_load_dwordx4 v150, s[44:47], s89 offen offset:0 lds
    ds_read_b64_tr_b16 v[112:113], v24 offset:4096
    v_mfma_f32_16x16x32_bf16 v[212:215], a[68:71], v[100:103], v[212:215]
    ds_read_b64_tr_b16 v[114:115], v24 offset:4608
    v_mfma_f32_16x16x32_bf16 v[216:219], a[72:75], v[100:103], v[216:219]
    buffer_load_dwordx4 v151, s[44:47], s89 offen offset:1024 lds
    ds_read_b64_tr_b16 v[116:117], v25 offset:4096
    v_mfma_f32_16x16x32_bf16 v[220:223], a[76:79], v[100:103], v[220:223]
    s_add_u32 m0, s91, 57344
    v_mfma_f32_16x16x32_bf16 v[224:227], a[64:67], v[104:107], v[224:227]
    ds_read_b64_tr_b16 v[118:119], v25 offset:4608
    ds_read_b64_tr_b16 v[120:121], v24 offset:12288
    v_mfma_f32_16x16x32_bf16 v[228:231], a[68:71], v[104:107], v[228:231]
    buffer_load_dwordx4 v152, s[44:47], s89 offen offset:0 lds
    v_mfma_f32_16x16x32_bf16 v[232:235], a[72:75], v[104:107], v[232:235]
    ds_read_b64_tr_b16 v[122:123], v24 offset:12800
    ds_read_b64_tr_b16 v[124:125], v25 offset:12288
    v_mfma_f32_16x16x32_bf16 v[236:239], a[76:79], v[104:107], v[236:239]
    buffer_load_dwordx4 v153, s[44:47], s89 offen offset:1024 lds
    v_mfma_f32_16x16x32_bf16 v[240:243], a[64:67], v[108:111], v[240:243]
    ds_read_b64_tr_b16 v[126:127], v25 offset:12800
    v_mfma_f32_16x16x32_bf16 v[244:247], a[68:71], v[108:111], v[244:247]
    v_mfma_f32_16x16x32_bf16 v[248:251], a[72:75], v[108:111], v[248:251]
    v_mfma_f32_16x16x32_bf16 v[252:255], a[76:79], v[108:111], v[252:255]
    s_waitcnt lgkmcnt(0)
    v_mfma_f32_16x16x32_bf16 v[192:195], a[80:83], v[112:115], v[192:195]
    s_waitcnt vmcnt(8)
    s_barrier
    v_mfma_f32_16x16x32_bf16 v[196:199], a[84:87], v[112:115], v[196:199]
    ds_read_b128 a[96:99], v18 offset:0
    v_mfma_f32_16x16x32_bf16 v[200:203], a[88:91], v[112:115], v[200:203]
    ds_read_b128 a[100:103], v18 offset:2048
    v_mfma_f32_16x16x32_bf16 v[204:207], a[92:95], v[112:115], v[204:207]
    s_add_u32 m0, s90, 65536
    ds_read_b128 a[104:107], v18 offset:4096
    v_mfma_f32_16x16x32_bf16 v[208:211], a[80:83], v[116:119], v[208:211]
    ds_read_b128 a[108:111], v18 offset:6144
    s_mov_b32 s88, 640
    v_mfma_f32_16x16x32_bf16 v[212:215], a[84:87], v[116:119], v[212:215]
    ds_read_b64_tr_b16 v[96:97], v22 offset:0
    v_mfma_f32_16x16x32_bf16 v[216:219], a[88:91], v[116:119], v[216:219]
    ds_read_b64_tr_b16 v[98:99], v22 offset:512
    buffer_load_dwordx4 v144, s[40:43], s88 offen offset:0 lds
    v_mfma_f32_16x16x32_bf16 v[220:223], a[92:95], v[116:119], v[220:223]
    ds_read_b64_tr_b16 v[100:101], v23 offset:0
    v_mfma_f32_16x16x32_bf16 v[224:227], a[80:83], v[120:123], v[224:227]
    buffer_load_dwordx4 v145, s[40:43], s88 offen offset:1024 lds
    ds_read_b64_tr_b16 v[102:103], v23 offset:512
    v_mfma_f32_16x16x32_bf16 v[228:231], a[84:87], v[120:123], v[228:231]
    ds_read_b64_tr_b16 v[104:105], v22 offset:8192
    buffer_load_dwordx4 v146, s[40:43], s88 offen offset:2048 lds
    v_mfma_f32_16x16x32_bf16 v[232:235], a[88:91], v[120:123], v[232:235]
    ds_read_b64_tr_b16 v[106:107], v22 offset:8704
    v_mfma_f32_16x16x32_bf16 v[236:239], a[92:95], v[120:123], v[236:239]
    ds_read_b64_tr_b16 v[108:109], v23 offset:8192
    buffer_load_dwordx4 v147, s[40:43], s88 offen offset:3072 lds
    v_mfma_f32_16x16x32_bf16 v[240:243], a[80:83], v[124:127], v[240:243]
    ds_read_b64_tr_b16 v[110:111], v23 offset:8704
    v_mfma_f32_16x16x32_bf16 v[244:247], a[84:87], v[124:127], v[244:247]
    v_mfma_f32_16x16x32_bf16 v[248:251], a[88:91], v[124:127], v[248:251]
    v_mfma_f32_16x16x32_bf16 v[252:255], a[92:95], v[124:127], v[252:255]
    s_waitcnt lgkmcnt(0)
    v_mfma_f32_16x16x32_bf16 v[192:195], a[96:99], v[96:99], v[192:195]
    ds_read_b128 a[112:115], v19 offset:0
    s_add_u32 m0, s91, 81920
    v_mfma_f32_16x16x32_bf16 v[196:199], a[100:103], v[96:99], v[196:199]
    ds_read_b128 a[116:119], v19 offset:2048
    v_mfma_f32_16x16x32_bf16 v[200:203], a[104:107], v[96:99], v[200:203]
    s_mov_b32 s89, 983040
    ds_read_b128 a[120:123], v19 offset:4096
    v_mfma_f32_16x16x32_bf16 v[204:207], a[108:111], v[96:99], v[204:207]
    ds_read_b128 a[124:127], v19 offset:6144
    v_mfma_f32_16x16x32_bf16 v[208:211], a[96:99], v[100:103], v[208:211]
    buffer_load_dwordx4 v150, s[44:47], s89 offen offset:0 lds
    ds_read_b64_tr_b16 v[112:113], v22 offset:4096
    v_mfma_f32_16x16x32_bf16 v[212:215], a[100:103], v[100:103], v[212:215]
    ds_read_b64_tr_b16 v[114:115], v22 offset:4608
    v_mfma_f32_16x16x32_bf16 v[216:219], a[104:107], v[100:103], v[216:219]
    buffer_load_dwordx4 v151, s[44:47], s89 offen offset:1024 lds
    ds_read_b64_tr_b16 v[116:117], v23 offset:4096
    v_mfma_f32_16x16x32_bf16 v[220:223], a[108:111], v[100:103], v[220:223]
    s_add_u32 m0, s91, 90112
    v_mfma_f32_16x16x32_bf16 v[224:227], a[96:99], v[104:107], v[224:227]
    ds_read_b64_tr_b16 v[118:119], v23 offset:4608
    ds_read_b64_tr_b16 v[120:121], v22 offset:12288
    v_mfma_f32_16x16x32_bf16 v[228:231], a[100:103], v[104:107], v[228:231]
    buffer_load_dwordx4 v152, s[44:47], s89 offen offset:0 lds
    v_mfma_f32_16x16x32_bf16 v[232:235], a[104:107], v[104:107], v[232:235]
    ds_read_b64_tr_b16 v[122:123], v22 offset:12800
    ds_read_b64_tr_b16 v[124:125], v23 offset:12288
    v_mfma_f32_16x16x32_bf16 v[236:239], a[108:111], v[104:107], v[236:239]
    buffer_load_dwordx4 v153, s[44:47], s89 offen offset:1024 lds
    v_mfma_f32_16x16x32_bf16 v[240:243], a[96:99], v[108:111], v[240:243]
    ds_read_b64_tr_b16 v[126:127], v23 offset:12800
    v_mfma_f32_16x16x32_bf16 v[244:247], a[100:103], v[108:111], v[244:247]
    v_mfma_f32_16x16x32_bf16 v[248:251], a[104:107], v[108:111], v[248:251]
    v_mfma_f32_16x16x32_bf16 v[252:255], a[108:111], v[108:111], v[252:255]
    s_waitcnt lgkmcnt(0)
    v_mfma_f32_16x16x32_bf16 v[192:195], a[112:115], v[112:115], v[192:195]
    s_waitcnt vmcnt(8)
    s_barrier
    v_mfma_f32_16x16x32_bf16 v[196:199], a[116:119], v[112:115], v[196:199]
    ds_read_b128 a[128:131], v18 offset:32768
    v_mfma_f32_16x16x32_bf16 v[200:203], a[120:123], v[112:115], v[200:203]
    ds_read_b128 a[132:135], v18 offset:34816
    v_mfma_f32_16x16x32_bf16 v[204:207], a[124:127], v[112:115], v[204:207]
    s_add_u32 m0, s90, 0
    ds_read_b128 a[136:139], v18 offset:36864
    v_mfma_f32_16x16x32_bf16 v[208:211], a[112:115], v[116:119], v[208:211]
    ds_read_b128 a[140:143], v18 offset:38912
    s_mov_b32 s88, 768
    v_mfma_f32_16x16x32_bf16 v[212:215], a[116:119], v[116:119], v[212:215]
    ds_read_b64_tr_b16 v[96:97], v22 offset:32768
    v_mfma_f32_16x16x32_bf16 v[216:219], a[120:123], v[116:119], v[216:219]
    ds_read_b64_tr_b16 v[98:99], v22 offset:33280
    buffer_load_dwordx4 v144, s[40:43], s88 offen offset:0 lds
    v_mfma_f32_16x16x32_bf16 v[220:223], a[124:127], v[116:119], v[220:223]
    ds_read_b64_tr_b16 v[100:101], v23 offset:32768
    v_mfma_f32_16x16x32_bf16 v[224:227], a[112:115], v[120:123], v[224:227]
    buffer_load_dwordx4 v145, s[40:43], s88 offen offset:1024 lds
    ds_read_b64_tr_b16 v[102:103], v23 offset:33280
    v_mfma_f32_16x16x32_bf16 v[228:231], a[116:119], v[120:123], v[228:231]
    ds_read_b64_tr_b16 v[104:105], v22 offset:40960
    buffer_load_dwordx4 v146, s[40:43], s88 offen offset:2048 lds
    v_mfma_f32_16x16x32_bf16 v[232:235], a[120:123], v[120:123], v[232:235]
    ds_read_b64_tr_b16 v[106:107], v22 offset:41472
    v_mfma_f32_16x16x32_bf16 v[236:239], a[124:127], v[120:123], v[236:239]
    ds_read_b64_tr_b16 v[108:109], v23 offset:40960
    buffer_load_dwordx4 v147, s[40:43], s88 offen offset:3072 lds
    v_mfma_f32_16x16x32_bf16 v[240:243], a[112:115], v[124:127], v[240:243]
    ds_read_b64_tr_b16 v[110:111], v23 offset:41472
    v_mfma_f32_16x16x32_bf16 v[244:247], a[116:119], v[124:127], v[244:247]
    v_mfma_f32_16x16x32_bf16 v[248:251], a[120:123], v[124:127], v[248:251]
    v_mfma_f32_16x16x32_bf16 v[252:255], a[124:127], v[124:127], v[252:255]
    s_waitcnt lgkmcnt(0)
    v_mfma_f32_16x16x32_bf16 v[192:195], a[128:131], v[96:99], v[192:195]
    ds_read_b128 a[144:147], v19 offset:32768
    s_add_u32 m0, s91, 16384
    v_mfma_f32_16x16x32_bf16 v[196:199], a[132:135], v[96:99], v[196:199]
    ds_read_b128 a[148:151], v19 offset:34816
    v_mfma_f32_16x16x32_bf16 v[200:203], a[136:139], v[96:99], v[200:203]
    s_mov_b32 s89, 1179648
    ds_read_b128 a[152:155], v19 offset:36864
    v_mfma_f32_16x16x32_bf16 v[204:207], a[140:143], v[96:99], v[204:207]
    ds_read_b128 a[156:159], v19 offset:38912
    v_mfma_f32_16x16x32_bf16 v[208:211], a[128:131], v[100:103], v[208:211]
    buffer_load_dwordx4 v150, s[44:47], s89 offen offset:0 lds
    ds_read_b64_tr_b16 v[112:113], v22 offset:36864
    v_mfma_f32_16x16x32_bf16 v[212:215], a[132:135], v[100:103], v[212:215]
    ds_read_b64_tr_b16 v[114:115], v22 offset:37376
    v_mfma_f32_16x16x32_bf16 v[216:219], a[136:139], v[100:103], v[216:219]
    buffer_load_dwordx4 v151, s[44:47], s89 offen offset:1024 lds
    ds_read_b64_tr_b16 v[116:117], v23 offset:36864
    v_mfma_f32_16x16x32_bf16 v[220:223], a[140:143], v[100:103], v[220:223]
    s_add_u32 m0, s91, 24576
    v_mfma_f32_16x16x32_bf16 v[224:227], a[128:131], v[104:107], v[224:227]
    ds_read_b64_tr_b16 v[118:119], v23 offset:37376
    ds_read_b64_tr_b16 v[120:121], v22 offset:45056
    v_mfma_f32_16x16x32_bf16 v[228:231], a[132:135], v[104:107], v[228:231]
    buffer_load_dwordx4 v152, s[44:47], s89 offen offset:0 lds
    v_mfma_f32_16x16x32_bf16 v[232:235], a[136:139], v[104:107], v[232:235]
    ds_read_b64_tr_b16 v[122:123], v22 offset:45568
    ds_read_b64_tr_b16 v[124:125], v23 offset:45056
    v_mfma_f32_16x16x32_bf16 v[236:239], a[140:143], v[104:107], v[236:239]
    buffer_load_dwordx4 v153, s[44:47], s89 offen offset:1024 lds
    v_mfma_f32_16x16x32_bf16 v[240:243], a[128:131], v[108:111], v[240:243]
    ds_read_b64_tr_b16 v[126:127], v23 offset:45568
    v_mfma_f32_16x16x32_bf16 v[244:247], a[132:135], v[108:111], v[244:247]
    v_mfma_f32_16x16x32_bf16 v[248:251], a[136:139], v[108:111], v[248:251]
    v_mfma_f32_16x16x32_bf16 v[252:255], a[140:143], v[108:111], v[252:255]
    s_waitcnt lgkmcnt(0)
    v_mfma_f32_16x16x32_bf16 v[192:195], a[144:147], v[112:115], v[192:195]
    s_waitcnt vmcnt(8)
    s_barrier
    v_mfma_f32_16x16x32_bf16 v[196:199], a[148:151], v[112:115], v[196:199]
    ds_read_b128 a[160:163], v20 offset:0
    v_mfma_f32_16x16x32_bf16 v[200:203], a[152:155], v[112:115], v[200:203]
    ds_read_b128 a[164:167], v20 offset:2048
    v_mfma_f32_16x16x32_bf16 v[204:207], a[156:159], v[112:115], v[204:207]
    s_add_u32 m0, s90, 32768
    ds_read_b128 a[168:171], v20 offset:4096
    v_mfma_f32_16x16x32_bf16 v[208:211], a[144:147], v[116:119], v[208:211]
    ds_read_b128 a[172:175], v20 offset:6144
    s_mov_b32 s88, 896
    v_mfma_f32_16x16x32_bf16 v[212:215], a[148:151], v[116:119], v[212:215]
    ds_read_b64_tr_b16 v[96:97], v24 offset:0
    v_mfma_f32_16x16x32_bf16 v[216:219], a[152:155], v[116:119], v[216:219]
    ds_read_b64_tr_b16 v[98:99], v24 offset:512
    buffer_load_dwordx4 v144, s[40:43], s88 offen offset:0 lds
    v_mfma_f32_16x16x32_bf16 v[220:223], a[156:159], v[116:119], v[220:223]
    ds_read_b64_tr_b16 v[100:101], v25 offset:0
    v_mfma_f32_16x16x32_bf16 v[224:227], a[144:147], v[120:123], v[224:227]
    buffer_load_dwordx4 v145, s[40:43], s88 offen offset:1024 lds
    ds_read_b64_tr_b16 v[102:103], v25 offset:512
    v_mfma_f32_16x16x32_bf16 v[228:231], a[148:151], v[120:123], v[228:231]
    ds_read_b64_tr_b16 v[104:105], v24 offset:8192
    buffer_load_dwordx4 v146, s[40:43], s88 offen offset:2048 lds
    v_mfma_f32_16x16x32_bf16 v[232:235], a[152:155], v[120:123], v[232:235]
    ds_read_b64_tr_b16 v[106:107], v24 offset:8704
    v_mfma_f32_16x16x32_bf16 v[236:239], a[156:159], v[120:123], v[236:239]
    ds_read_b64_tr_b16 v[108:109], v25 offset:8192
    buffer_load_dwordx4 v147, s[40:43], s88 offen offset:3072 lds
    v_mfma_f32_16x16x32_bf16 v[240:243], a[144:147], v[124:127], v[240:243]
    ds_read_b64_tr_b16 v[110:111], v25 offset:8704
    v_mfma_f32_16x16x32_bf16 v[244:247], a[148:151], v[124:127], v[244:247]
    v_mfma_f32_16x16x32_bf16 v[248:251], a[152:155], v[124:127], v[248:251]
    v_mfma_f32_16x16x32_bf16 v[252:255], a[156:159], v[124:127], v[252:255]
    s_waitcnt lgkmcnt(0)
    v_mfma_f32_16x16x32_bf16 v[192:195], a[160:163], v[96:99], v[192:195]
    ds_read_b128 a[176:179], v21 offset:0
    s_add_u32 m0, s91, 49152
    v_mfma_f32_16x16x32_bf16 v[196:199], a[164:167], v[96:99], v[196:199]
    ds_read_b128 a[180:183], v21 offset:2048
    s_mov_b32 s89, 1376256
    v_mfma_f32_16x16x32_bf16 v[200:203], a[168:171], v[96:99], v[200:203]
    ds_read_b128 a[184:187], v21 offset:4096
    v_mfma_f32_16x16x32_bf16 v[204:207], a[172:175], v[96:99], v[204:207]
    buffer_load_dwordx4 v150, s[44:47], s89 offen offset:0 lds
    ds_read_b128 a[188:191], v21 offset:6144
    v_mfma_f32_16x16x32_bf16 v[208:211], a[160:163], v[100:103], v[208:211]
    ds_read_b64_tr_b16 v[112:113], v24 offset:4096
    buffer_load_dwordx4 v151, s[44:47], s89 offen offset:1024 lds
    v_mfma_f32_16x16x32_bf16 v[212:215], a[164:167], v[100:103], v[212:215]
    ds_read_b64_tr_b16 v[114:115], v24 offset:4608
    v_mfma_f32_16x16x32_bf16 v[216:219], a[168:171], v[100:103], v[216:219]
    s_add_u32 m0, s91, 57344
    ds_read_b64_tr_b16 v[116:117], v25 offset:4096
    v_mfma_f32_16x16x32_bf16 v[220:223], a[172:175], v[100:103], v[220:223]
    buffer_load_dwordx4 v152, s[44:47], s89 offen offset:0 lds
    v_mfma_f32_16x16x32_bf16 v[224:227], a[160:163], v[104:107], v[224:227]
    ds_read_b64_tr_b16 v[118:119], v25 offset:4608
    ds_read_b64_tr_b16 v[120:121], v24 offset:12288
    v_mfma_f32_16x16x32_bf16 v[228:231], a[164:167], v[104:107], v[228:231]
    buffer_load_dwordx4 v153, s[44:47], s89 offen offset:1024 lds
    ds_read_b64_tr_b16 v[122:123], v24 offset:12800
    v_mfma_f32_16x16x32_bf16 v[232:235], a[168:171], v[104:107], v[232:235]
    v_mov_b32 v158, 128
    v_mfma_f32_16x16x32_bf16 v[236:239], a[172:175], v[104:107], v[236:239]
    ds_read_b64_tr_b16 v[124:125], v25 offset:12288
    buffer_load_dword v159, v158, s[76:79], 0 offen sc1
    v_mfma_f32_16x16x32_bf16 v[240:243], a[160:163], v[108:111], v[240:243]
    ds_read_b64_tr_b16 v[126:127], v25 offset:12800
    v_mfma_f32_16x16x32_bf16 v[244:247], a[164:167], v[108:111], v[244:247]
    v_mfma_f32_16x16x32_bf16 v[248:251], a[168:171], v[108:111], v[248:251]
    v_mfma_f32_16x16x32_bf16 v[252:255], a[172:175], v[108:111], v[252:255]
    s_waitcnt lgkmcnt(0)
    v_mfma_f32_16x16x32_bf16 v[192:195], a[176:179], v[112:115], v[192:195]
    s_waitcnt vmcnt(9)
    s_barrier
    v_mfma_f32_16x16x32_bf16 v[196:199], a[180:183], v[112:115], v[196:199]
    ds_read_b128 a[192:195], v18 offset:0
    v_mfma_f32_16x16x32_bf16 v[200:203], a[184:187], v[112:115], v[200:203]
    ds_read_b128 a[196:199], v18 offset:2048
    s_add_u32 m0, s91, 98304
    v_mfma_f32_16x16x32_bf16 v[204:207], a[188:191], v[112:115], v[204:207]
    ds_read_b128 a[200:203], v18 offset:4096
    v_mfma_f32_16x16x32_bf16 v[208:211], a[176:179], v[116:119], v[208:211]
    ds_read_b128 a[204:207], v18 offset:6144
    s_mov_b32 s89, 0
    v_mfma_f32_16x16x32_bf16 v[212:215], a[180:183], v[116:119], v[212:215]
    ds_read_b64_tr_b16 v[96:97], v22 offset:0
    buffer_load_dwordx4 v148, s[44:47], s89 offen offset:0 lds
    v_mfma_f32_16x16x32_bf16 v[216:219], a[184:187], v[116:119], v[216:219]
    ds_read_b64_tr_b16 v[98:99], v22 offset:512
    v_mfma_f32_16x16x32_bf16 v[220:223], a[188:191], v[116:119], v[220:223]
    ds_read_b64_tr_b16 v[100:101], v23 offset:0
    buffer_load_dwordx4 v149, s[44:47], s89 offen offset:1024 lds
    v_mfma_f32_16x16x32_bf16 v[224:227], a[176:179], v[120:123], v[224:227]
    ds_read_b64_tr_b16 v[102:103], v23 offset:512
    s_add_u32 m0, s91, 106496
    v_mfma_f32_16x16x32_bf16 v[228:231], a[180:183], v[120:123], v[228:231]
    ds_read_b64_tr_b16 v[104:105], v22 offset:8192
    v_mfma_f32_16x16x32_bf16 v[232:235], a[184:187], v[120:123], v[232:235]
    ds_read_b64_tr_b16 v[106:107], v22 offset:8704
    s_mov_b32 s89, 196608
    v_mfma_f32_16x16x32_bf16 v[236:239], a[188:191], v[120:123], v[236:239]
    ds_read_b64_tr_b16 v[108:109], v23 offset:8192
    buffer_load_dwordx4 v148, s[44:47], s89 offen offset:0 lds
    v_mfma_f32_16x16x32_bf16 v[240:243], a[176:179], v[124:127], v[240:243]
    ds_read_b64_tr_b16 v[110:111], v23 offset:8704
    v_mfma_f32_16x16x32_bf16 v[244:247], a[180:183], v[124:127], v[244:247]
    v_mfma_f32_16x16x32_bf16 v[248:251], a[184:187], v[124:127], v[248:251]
    v_mfma_f32_16x16x32_bf16 v[252:255], a[188:191], v[124:127], v[252:255]
    s_waitcnt lgkmcnt(0)
    v_mfma_f32_16x16x32_bf16 v[192:195], a[192:195], v[96:99], v[192:195]
    ds_read_b128 a[208:211], v19 offset:0
    buffer_load_dwordx4 v149, s[44:47], s89 offen offset:1024 lds
    v_mfma_f32_16x16x32_bf16 v[196:199], a[196:199], v[96:99], v[196:199]
    ds_read_b128 a[212:215], v19 offset:2048
    s_add_u32 m0, s91, 114688
    v_mfma_f32_16x16x32_bf16 v[200:203], a[200:203], v[96:99], v[200:203]
    ds_read_b128 a[216:219], v19 offset:4096
    v_mfma_f32_16x16x32_bf16 v[204:207], a[204:207], v[96:99], v[204:207]
    ds_read_b128 a[220:223], v19 offset:6144
    s_mov_b32 s89, 393216
    v_mfma_f32_16x16x32_bf16 v[208:211], a[192:195], v[100:103], v[208:211]
    ds_read_b64_tr_b16 v[112:113], v22 offset:4096
    v_mfma_f32_16x16x32_bf16 v[212:215], a[196:199], v[100:103], v[212:215]
    buffer_load_dwordx4 v148, s[44:47], s89 offen offset:0 lds
    ds_read_b64_tr_b16 v[114:115], v22 offset:4608
    v_mfma_f32_16x16x32_bf16 v[216:219], a[200:203], v[100:103], v[216:219]
    ds_read_b64_tr_b16 v[116:117], v23 offset:4096
    v_mfma_f32_16x16x32_bf16 v[220:223], a[204:207], v[100:103], v[220:223]
    buffer_load_dwordx4 v149, s[44:47], s89 offen offset:1024 lds
    ds_read_b64_tr_b16 v[118:119], v23 offset:4608
    v_mfma_f32_16x16x32_bf16 v[224:227], a[192:195], v[104:107], v[224:227]
    s_add_u32 m0, s91, 122880
    v_mfma_f32_16x16x32_bf16 v[228:231], a[196:199], v[104:107], v[228:231]
    ds_read_b64_tr_b16 v[120:121], v22 offset:12288
    ds_read_b64_tr_b16 v[122:123], v22 offset:12800
    v_mfma_f32_16x16x32_bf16 v[232:235], a[200:203], v[104:107], v[232:235]
    s_mov_b32 s89, 589824
    v_mfma_f32_16x16x32_bf16 v[236:239], a[204:207], v[104:107], v[236:239]
    ds_read_b64_tr_b16 v[124:125], v23 offset:12288
    buffer_load_dwordx4 v148, s[44:47], s89 offen offset:0 lds
    v_mfma_f32_16x16x32_bf16 v[240:243], a[192:195], v[108:111], v[240:243]
    ds_read_b64_tr_b16 v[126:127], v23 offset:12800
    v_mfma_f32_16x16x32_bf16 v[244:247], a[196:199], v[108:111], v[244:247]
    v_mfma_f32_16x16x32_bf16 v[248:251], a[200:203], v[108:111], v[248:251]
    v_mfma_f32_16x16x32_bf16 v[252:255], a[204:207], v[108:111], v[252:255]
    s_waitcnt lgkmcnt(0)
    v_mfma_f32_16x16x32_bf16 v[192:195], a[208:211], v[112:115], v[192:195]
    s_waitcnt vmcnt(8)
    s_barrier
    v_mfma_f32_16x16x32_bf16 v[196:199], a[212:215], v[112:115], v[196:199]
    ds_read_b128 a[224:227], v18 offset:32768
    buffer_load_dwordx4 v149, s[44:47], s89 offen offset:1024 lds
    v_mfma_f32_16x16x32_bf16 v[200:203], a[216:219], v[112:115], v[200:203]
    ds_read_b128 a[228:231], v18 offset:34816
    s_add_u32 m0, s91, 131072
    v_mfma_f32_16x16x32_bf16 v[204:207], a[220:223], v[112:115], v[204:207]
    ds_read_b128 a[232:235], v18 offset:36864
    v_mfma_f32_16x16x32_bf16 v[208:211], a[208:211], v[116:119], v[208:211]
    ds_read_b128 a[236:239], v18 offset:38912
    s_mov_b32 s89, 786432
    v_mfma_f32_16x16x32_bf16 v[212:215], a[212:215], v[116:119], v[212:215]
    ds_read_b64_tr_b16 v[96:97], v22 offset:32768
    buffer_load_dwordx4 v148, s[44:47], s89 offen offset:0 lds
    v_mfma_f32_16x16x32_bf16 v[216:219], a[216:219], v[116:119], v[216:219]
    ds_read_b64_tr_b16 v[98:99], v22 offset:33280
    v_mfma_f32_16x16x32_bf16 v[220:223], a[220:223], v[116:119], v[220:223]
    ds_read_b64_tr_b16 v[100:101], v23 offset:32768
    buffer_load_dwordx4 v149, s[44:47], s89 offen offset:1024 lds
    v_mfma_f32_16x16x32_bf16 v[224:227], a[208:211], v[120:123], v[224:227]
    ds_read_b64_tr_b16 v[102:103], v23 offset:33280
    s_add_u32 m0, s91, 139264
    v_mfma_f32_16x16x32_bf16 v[228:231], a[212:215], v[120:123], v[228:231]
    ds_read_b64_tr_b16 v[104:105], v22 offset:40960
    v_mfma_f32_16x16x32_bf16 v[232:235], a[216:219], v[120:123], v[232:235]
    ds_read_b64_tr_b16 v[106:107], v22 offset:41472
    s_mov_b32 s89, 983040
    v_mfma_f32_16x16x32_bf16 v[236:239], a[220:223], v[120:123], v[236:239]
    ds_read_b64_tr_b16 v[108:109], v23 offset:40960
    buffer_load_dwordx4 v148, s[44:47], s89 offen offset:0 lds
    v_mfma_f32_16x16x32_bf16 v[240:243], a[208:211], v[124:127], v[240:243]
    ds_read_b64_tr_b16 v[110:111], v23 offset:41472
    v_mfma_f32_16x16x32_bf16 v[244:247], a[212:215], v[124:127], v[244:247]
    v_mfma_f32_16x16x32_bf16 v[248:251], a[216:219], v[124:127], v[248:251]
    v_mfma_f32_16x16x32_bf16 v[252:255], a[220:223], v[124:127], v[252:255]
    s_waitcnt lgkmcnt(0)
    v_mfma_f32_16x16x32_bf16 v[192:195], a[224:227], v[96:99], v[192:195]
    ds_read_b128 a[240:243], v19 offset:32768
    buffer_load_dwordx4 v149, s[44:47], s89 offen offset:1024 lds
    v_mfma_f32_16x16x32_bf16 v[196:199], a[228:231], v[96:99], v[196:199]
    ds_read_b128 a[244:247], v19 offset:34816
    s_add_u32 m0, s91, 147456
    v_mfma_f32_16x16x32_bf16 v[200:203], a[232:235], v[96:99], v[200:203]
    ds_read_b128 a[248:251], v19 offset:36864
    v_mfma_f32_16x16x32_bf16 v[204:207], a[236:239], v[96:99], v[204:207]
    ds_read_b128 a[252:255], v19 offset:38912
    s_mov_b32 s89, 1179648
    v_mfma_f32_16x16x32_bf16 v[208:211], a[224:227], v[100:103], v[208:211]
    ds_read_b64_tr_b16 v[112:113], v22 offset:36864
    v_mfma_f32_16x16x32_bf16 v[212:215], a[228:231], v[100:103], v[212:215]
    buffer_load_dwordx4 v148, s[44:47], s89 offen offset:0 lds
    ds_read_b64_tr_b16 v[114:115], v22 offset:37376
    v_mfma_f32_16x16x32_bf16 v[216:219], a[232:235], v[100:103], v[216:219]
    ds_read_b64_tr_b16 v[116:117], v23 offset:36864
    v_mfma_f32_16x16x32_bf16 v[220:223], a[236:239], v[100:103], v[220:223]
    buffer_load_dwordx4 v149, s[44:47], s89 offen offset:1024 lds
    ds_read_b64_tr_b16 v[118:119], v23 offset:37376
    v_mfma_f32_16x16x32_bf16 v[224:227], a[224:227], v[104:107], v[224:227]
    s_add_u32 m0, s91, 155648
    v_mfma_f32_16x16x32_bf16 v[228:231], a[228:231], v[104:107], v[228:231]
    ds_read_b64_tr_b16 v[120:121], v22 offset:45056
    ds_read_b64_tr_b16 v[122:123], v22 offset:45568
    v_mfma_f32_16x16x32_bf16 v[232:235], a[232:235], v[104:107], v[232:235]
    s_mov_b32 s89, 1376256
    v_mfma_f32_16x16x32_bf16 v[236:239], a[236:239], v[104:107], v[236:239]
    ds_read_b64_tr_b16 v[124:125], v23 offset:45056
    buffer_load_dwordx4 v148, s[44:47], s89 offen offset:0 lds
    v_mfma_f32_16x16x32_bf16 v[240:243], a[224:227], v[108:111], v[240:243]
    ds_read_b64_tr_b16 v[126:127], v23 offset:45568
    v_mfma_f32_16x16x32_bf16 v[244:247], a[228:231], v[108:111], v[244:247]
    v_mfma_f32_16x16x32_bf16 v[248:251], a[232:235], v[108:111], v[248:251]
    v_mfma_f32_16x16x32_bf16 v[252:255], a[236:239], v[108:111], v[252:255]
    s_waitcnt lgkmcnt(0)
    v_mfma_f32_16x16x32_bf16 v[192:195], a[240:243], v[112:115], v[192:195]
    buffer_load_dwordx4 v149, s[44:47], s89 offen offset:1024 lds
    s_mov_b32 s101, 0
    buffer_load_dword v157, v154, s[60:63], s101 offen
    v_mfma_f32_16x16x32_bf16 v[196:199], a[244:247], v[112:115], v[196:199]
    s_mov_b32 s92, 0x3fb8aa3b
    s_mov_b32 s93, 0x3fb8aa3b
    v_mfma_f32_16x16x32_bf16 v[200:203], a[248:251], v[112:115], v[200:203]
    s_mov_b32 s94, 0x358637bd
    s_mov_b32 s95, 0x358637bd
    v_mfma_f32_16x16x32_bf16 v[204:207], a[252:255], v[112:115], v[204:207]
    v_mov_b32 v26, s85
    v_mov_b32 v27, s85
    v_mfma_f32_16x16x32_bf16 v[208:211], a[240:243], v[116:119], v[208:211]
    v_mov_b32 v28, s85
    v_mov_b32 v29, s85
    v_mfma_f32_16x16x32_bf16 v[212:215], a[244:247], v[116:119], v[212:215]
    s_lshl_b32 s12, s3, 11
    s_add_u32 s12, s12, 65536
    v_mfma_f32_16x16x32_bf16 v[216:219], a[248:251], v[116:119], v[216:219]
    v_add_u32 v6, s12, v4
    v_xor_b32 v7, 4096, v6
    v_mfma_f32_16x16x32_bf16 v[220:223], a[252:255], v[116:119], v[220:223]
    s_lshl_b32 s15, s9, 2
    s_lshl_b32 s12, s97, 1
    v_mfma_f32_16x16x32_bf16 v[224:227], a[240:243], v[120:123], v[224:227]
    s_add_u32 s15, s15, s12
    s_add_u32 s15, s15, s96
    v_mfma_f32_16x16x32_bf16 v[228:231], a[244:247], v[120:123], v[228:231]
    s_lshl_b32 s13, s15, 10
    s_add_u32 s13, s13, 6291456
    v_mfma_f32_16x16x32_bf16 v[232:235], a[248:251], v[120:123], v[232:235]
    s_lshl_b32 s12, s15, 6
    s_add_u32 s12, s12, 6324224
    v_mfma_f32_16x16x32_bf16 v[236:239], a[252:255], v[120:123], v[236:239]
    v_lshlrev_b32 v10, 2, v1
    v_lshlrev_b32 v8, 4, v3
    v_mfma_f32_16x16x32_bf16 v[240:243], a[240:243], v[124:127], v[240:243]
    v_lshl_add_u32 v8, v2, 2, v8
    v_cmp_gt_u32 vcc, 4, v2
    v_mfma_f32_16x16x32_bf16 v[244:247], a[244:247], v[124:127], v[244:247]
    v_mov_b32 v9, 0x7ffffff0
    s_nop 0
    v_mfma_f32_16x16x32_bf16 v[248:251], a[248:251], v[124:127], v[248:251]
    v_cndmask_b32 v8, v9, v8, vcc
    s_nop 0
    v_mfma_f32_16x16x32_bf16 v[252:255], a[252:255], v[124:127], v[252:255]
    v_pk_mul_f32 v[64:65], v[192:193], s[92:93]
    v_pk_mul_f32 v[66:67], v[194:195], s[92:93]
    v_pk_mul_f32 v[68:69], v[196:197], s[92:93]
    v_pk_mul_f32 v[70:71], v[198:199], s[92:93]
    v_pk_mul_f32 v[72:73], v[200:201], s[92:93]
    v_pk_mul_f32 v[74:75], v[202:203], s[92:93]
    v_pk_mul_f32 v[76:77], v[204:205], s[92:93]
    v_pk_mul_f32 v[78:79], v[206:207], s[92:93]
    v_pk_mul_f32 v[80:81], v[208:209], s[92:93]
    v_pk_mul_f32 v[82:83], v[210:211], s[92:93]
    v_pk_mul_f32 v[84:85], v[212:213], s[92:93]
    v_pk_mul_f32 v[86:87], v[214:215], s[92:93]
    v_pk_mul_f32 v[88:89], v[216:217], s[92:93]
    v_pk_mul_f32 v[90:91], v[218:219], s[92:93]
    v_pk_mul_f32 v[92:93], v[220:221], s[92:93]
    v_pk_mul_f32 v[94:95], v[222:223], s[92:93]
    v_exp_f32 v64, v64 clamp
    v_max_f32 v192, 0, v192
    v_exp_f32 v65, v65 clamp
    v_max_f32 v193, 0, v193
    v_exp_f32 v66, v66 clamp
    v_max_f32 v194, 0, v194
    v_exp_f32 v67, v67 clamp
    v_max_f32 v195, 0, v195
    v_exp_f32 v68, v68 clamp
    v_max_f32 v196, 0, v196
    v_exp_f32 v69, v69 clamp
    v_max_f32 v197, 0, v197
    v_exp_f32 v70, v70 clamp
    v_max_f32 v198, 0, v198
    v_exp_f32 v71, v71 clamp
    v_max_f32 v199, 0, v199
    v_exp_f32 v72, v72 clamp
    v_max_f32 v200, 0, v200
    v_exp_f32 v73, v73 clamp
    v_max_f32 v201, 0, v201
    v_exp_f32 v74, v74 clamp
    v_max_f32 v202, 0, v202
    v_exp_f32 v75, v75 clamp
    v_max_f32 v203, 0, v203
    v_exp_f32 v76, v76 clamp
    v_max_f32 v204, 0, v204
    v_exp_f32 v77, v77 clamp
    v_max_f32 v205, 0, v205
    v_exp_f32 v78, v78 clamp
    v_max_f32 v206, 0, v206
    v_exp_f32 v79, v79 clamp
    v_max_f32 v207, 0, v207
    v_exp_f32 v80, v80 clamp
    v_max_f32 v208, 0, v208
    v_exp_f32 v81, v81 clamp
    v_max_f32 v209, 0, v209
    v_exp_f32 v82, v82 clamp
    v_max_f32 v210, 0, v210
    v_exp_f32 v83, v83 clamp
    v_max_f32 v211, 0, v211
    v_exp_f32 v84, v84 clamp
    v_max_f32 v212, 0, v212
    v_exp_f32 v85, v85 clamp
    v_max_f32 v213, 0, v213
    v_exp_f32 v86, v86 clamp
    v_max_f32 v214, 0, v214
    v_exp_f32 v87, v87 clamp
    v_max_f32 v215, 0, v215
    v_exp_f32 v88, v88 clamp
    v_max_f32 v216, 0, v216
    v_exp_f32 v89, v89 clamp
    v_max_f32 v217, 0, v217
    v_exp_f32 v90, v90 clamp
    v_max_f32 v218, 0, v218
    v_exp_f32 v91, v91 clamp
    v_max_f32 v219, 0, v219
    v_exp_f32 v92, v92 clamp
    v_max_f32 v220, 0, v220
    v_exp_f32 v93, v93 clamp
    v_max_f32 v221, 0, v221
    v_exp_f32 v94, v94 clamp
    v_max_f32 v222, 0, v222
    v_exp_f32 v95, v95 clamp
    v_max_f32 v223, 0, v223
    v_pk_add_f32 v[64:65], v[64:65], s[94:95]
    v_pk_add_f32 v[66:67], v[66:67], s[94:95]
    v_pk_add_f32 v[68:69], v[68:69], s[94:95]
    v_pk_add_f32 v[70:71], v[70:71], s[94:95]
    v_pk_add_f32 v[72:73], v[72:73], s[94:95]
    v_pk_add_f32 v[74:75], v[74:75], s[94:95]
    v_pk_add_f32 v[76:77], v[76:77], s[94:95]
    v_pk_add_f32 v[78:79], v[78:79], s[94:95]
    v_pk_add_f32 v[80:81], v[80:81], s[94:95]
    v_pk_add_f32 v[82:83], v[82:83], s[94:95]
    v_pk_add_f32 v[84:85], v[84:85], s[94:95]
    v_pk_add_f32 v[86:87], v[86:87], s[94:95]
    v_pk_add_f32 v[88:89], v[88:89], s[94:95]
    v_pk_add_f32 v[90:91], v[90:91], s[94:95]
    v_pk_add_f32 v[92:93], v[92:93], s[94:95]
    v_pk_add_f32 v[94:95], v[94:95], s[94:95]
    v_pk_add_f32 v[64:65], v[64:65], v[192:193]
    v_pk_add_f32 v[66:67], v[66:67], v[194:195]
    v_pk_add_f32 v[68:69], v[68:69], v[196:197]
    v_pk_add_f32 v[70:71], v[70:71], v[198:199]
    v_pk_add_f32 v[72:73], v[72:73], v[200:201]
    v_pk_add_f32 v[74:75], v[74:75], v[202:203]
    v_pk_add_f32 v[76:77], v[76:77], v[204:205]
    v_pk_add_f32 v[78:79], v[78:79], v[206:207]
    v_pk_add_f32 v[80:81], v[80:81], v[208:209]
    v_pk_add_f32 v[82:83], v[82:83], v[210:211]
    v_pk_add_f32 v[84:85], v[84:85], v[212:213]
    v_pk_add_f32 v[86:87], v[86:87], v[214:215]
    v_pk_add_f32 v[88:89], v[88:89], v[216:217]
    v_pk_add_f32 v[90:91], v[90:91], v[218:219]
    v_pk_add_f32 v[92:93], v[92:93], v[220:221]
    v_pk_add_f32 v[94:95], v[94:95], v[222:223]
    v_cvt_pk_bf16_f32 v96, v64, v65
    v_cvt_pk_bf16_f32 v97, v66, v67
    v_cvt_pk_bf16_f32 v98, v68, v69
    v_cvt_pk_bf16_f32 v99, v70, v71
    v_cvt_pk_bf16_f32 v100, v72, v73
    v_cvt_pk_bf16_f32 v101, v74, v75
    v_cvt_pk_bf16_f32 v102, v76, v77
    v_cvt_pk_bf16_f32 v103, v78, v79
    v_cvt_pk_bf16_f32 v104, v80, v81
    v_cvt_pk_bf16_f32 v105, v82, v83
    v_cvt_pk_bf16_f32 v106, v84, v85
    v_cvt_pk_bf16_f32 v107, v86, v87
    v_cvt_pk_bf16_f32 v108, v88, v89
    v_cvt_pk_bf16_f32 v109, v90, v91
    v_cvt_pk_bf16_f32 v110, v92, v93
    v_cvt_pk_bf16_f32 v111, v94, v95
    v_cvt_pk_bf16_f32 v112, v224, v225
    v_cvt_pk_bf16_f32 v113, v226, v227
    v_cvt_pk_bf16_f32 v114, v228, v229
    v_cvt_pk_bf16_f32 v115, v230, v231
    v_cvt_pk_bf16_f32 v116, v232, v233
    v_cvt_pk_bf16_f32 v117, v234, v235
    v_cvt_pk_bf16_f32 v118, v236, v237
    v_cvt_pk_bf16_f32 v119, v238, v239
    v_cvt_pk_bf16_f32 v120, v240, v241
    v_cvt_pk_bf16_f32 v121, v242, v243
    v_cvt_pk_bf16_f32 v122, v244, v245
    v_cvt_pk_bf16_f32 v123, v246, v247
    v_cvt_pk_bf16_f32 v124, v248, v249
    v_cvt_pk_bf16_f32 v125, v250, v251
    v_cvt_pk_bf16_f32 v126, v252, v253
    v_cvt_pk_bf16_f32 v127, v254, v255
    v_cmp_eq_u32 s[88:89], 1, v2
    v_cmp_eq_u32 s[90:91], 2, v2
    v_mfma_f32_16x16x32_bf16 v[32:35], v[96:99], v[112:115], 0
    v_mfma_f32_16x16x32_bf16 v[36:39], v[96:99], v[26:29], 0
    v_mfma_f32_16x16x32_bf16 v[32:35], v[100:103], v[116:119], v[32:35]
    v_mfma_f32_16x16x32_bf16 v[36:39], v[100:103], v[26:29], v[36:39]
    v_mfma_f32_16x16x32_bf16 v[40:43], v[104:107], v[120:123], 0
    v_mfma_f32_16x16x32_bf16 v[44:47], v[104:107], v[26:29], 0
    v_mfma_f32_16x16x32_bf16 v[40:43], v[108:111], v[124:127], v[40:43]
    v_mfma_f32_16x16x32_bf16 v[44:47], v[108:111], v[26:29], v[44:47]
    s_nop 3
    ds_write_b128 v6, v[32:35]
    ds_write_b128 v6, v[36:39] offset:1024
    s_waitcnt vmcnt(1)
    v_cmp_gt_u32 vcc, 1, v159
    s_cbranch_vccz L_z_8
    s_mov_b32 s14, 0
L_poll_9:
    buffer_load_dword v31, v158, s[76:79], 0 offen sc1
    s_add_u32 s14, s14, 1
    s_waitcnt vmcnt(0)
    v_cmp_gt_u32 vcc, 1, v31
    s_cbranch_vccz L_polled_10
    s_sleep 1
    s_cmp_lt_u32 s14, 0x40000
    s_cbranch_scc1 L_poll_9
L_polled_10:
L_z_8:
    v_cmp_eq_u32 vcc, 3, v2
    s_waitcnt lgkmcnt(0)
    s_barrier
    ds_read_b128 v[32:35], v7
    ds_read_b128 v[36:39], v7 offset:1024
    ds_read_b64_tr_b16 v[64:65], v14 offset:0
    ds_read_b64_tr_b16 v[66:67], v14 offset:512
    ds_read_b64_tr_b16 v[68:69], v15 offset:0
    ds_read_b64_tr_b16 v[70:71], v15 offset:512
    ds_read_b64_tr_b16 v[72:73], v14 offset:4096
    ds_read_b64_tr_b16 v[74:75], v14 offset:4608
    ds_read_b64_tr_b16 v[76:77], v15 offset:4096
    ds_read_b64_tr_b16 v[78:79], v15 offset:4608
    s_waitcnt lgkmcnt(8)
    v_pk_add_f32 v[32:33], v[32:33], v[40:41]
    v_pk_add_f32 v[34:35], v[34:35], v[42:43]
    v_pk_add_f32 v[36:37], v[36:37], v[44:45]
    v_pk_add_f32 v[38:39], v[38:39], v[46:47]
    buffer_atomic_add_f32 v32, v10, s[80:83], s13 offen offset:0
    buffer_atomic_add_f32 v33, v10, s[80:83], s13 offen offset:256
    buffer_atomic_add_f32 v34, v10, s[80:83], s13 offen offset:512
    buffer_atomic_add_f32 v35, v10, s[80:83], s13 offen offset:768
    v_cndmask_b32 v36, v36, v37, s[88:89]
    v_cndmask_b32 v36, v36, v38, s[90:91]
    v_cndmask_b32 v36, v36, v39, vcc
    buffer_atomic_add_f32 v36, v8, s[80:83], s12 offen
    s_lshl_b32 s90, s9, 10
    s_add_u32 s90, s90, 6946816
    s_lshl_b32 s13, s4, 8
    s_add_u32 s13, s13, s90
    v_mov_b32 v8, s13
    s_waitcnt lgkmcnt(0)
    v_mfma_f32_16x16x32_bf16 v[160:163], v[64:67], a[0:3], 0
    ds_read_b64_tr_b16 v[80:81], v14 offset:8192
    s_mul_i32 s100, s3, 24576
    v_mfma_f32_16x16x32_bf16 v[164:167], v[64:67], a[4:7], 0
    s_lshl_b32 s99, s3, 14
    ds_read_b64_tr_b16 v[82:83], v14 offset:8704
    v_mfma_f32_16x16x32_bf16 v[168:171], v[64:67], a[8:11], 0
    s_add_u32 s99, s99, 98304
    v_lshrrev_b32 v30, 3, v1
    v_mfma_f32_16x16x32_bf16 v[172:175], v[64:67], a[12:15], 0
    ds_read_b64_tr_b16 v[84:85], v15 offset:8192
    v_and_b32 v31, 7, v1
    v_mfma_f32_16x16x32_bf16 v[176:179], v[68:71], a[0:3], 0
    v_and_b32 v22, 6, v30
    v_mfma_f32_16x16x32_bf16 v[180:183], v[68:71], a[4:7], 0
    ds_read_b64_tr_b16 v[86:87], v15 offset:8704
    v_xor_b32 v31, v31, v22
    v_mfma_f32_16x16x32_bf16 v[184:187], v[68:71], a[8:11], 0
    v_lshlrev_b32 v31, 4, v31
    ds_read_b64_tr_b16 v[88:89], v14 offset:12288
    v_mfma_f32_16x16x32_bf16 v[188:191], v[68:71], a[12:15], 0
    v_lshl_add_u32 v22, v30, 12, v31
    v_lshl_add_u32 v250, v30, 10, v31
    v_mfma_f32_16x16x32_bf16 v[160:163], v[72:75], a[16:19], v[160:163]
    ds_read_b64_tr_b16 v[90:91], v14 offset:12800
    v_mfma_f32_16x16x32_bf16 v[164:167], v[72:75], a[20:23], v[164:167]
    s_lshl_b32 s13, s11, 7
    s_lshl_b32 s87, s3, 5
    v_mfma_f32_16x16x32_bf16 v[168:171], v[72:75], a[24:27], v[168:171]
    ds_read_b64_tr_b16 v[92:93], v15 offset:12288
    s_add_u32 s87, s87, s13
    v_mfma_f32_16x16x32_bf16 v[172:175], v[72:75], a[28:31], v[172:175]
    s_lshl_b32 s12, s3, 17
    ds_read_b64_tr_b16 v[94:95], v15 offset:12800
    v_mfma_f32_16x16x32_bf16 v[176:179], v[76:79], a[16:19], v[176:179]
    s_add_u32 s12, s12, s13
    v_mfma_f32_16x16x32_bf16 v[180:183], v[76:79], a[20:23], v[180:183]
    v_mfma_f32_16x16x32_bf16 v[184:187], v[76:79], a[24:27], v[184:187]
    v_mfma_f32_16x16x32_bf16 v[188:191], v[76:79], a[28:31], v[188:191]
    s_waitcnt lgkmcnt(0)
    v_mfma_f32_16x16x32_bf16 v[160:163], v[80:83], a[32:35], v[160:163]
    ds_read_b64_tr_b16 v[64:65], v14 offset:16384
    v_add_u32 v250, s12, v250
    v_mfma_f32_16x16x32_bf16 v[164:167], v[80:83], a[36:39], v[164:167]
    s_mul_i32 s12, s3, 1441792
    ds_read_b64_tr_b16 v[66:67], v14 offset:16896
    v_mfma_f32_16x16x32_bf16 v[168:171], v[80:83], a[40:43], v[168:171]
    s_lshl_b32 s13, s10, 7
    s_add_u32 s12, s12, s13
    v_mfma_f32_16x16x32_bf16 v[172:175], v[80:83], a[44:47], v[172:175]
    ds_read_b64_tr_b16 v[68:69], v15 offset:16384
    v_add_u32 v22, s12, v22
    v_mfma_f32_16x16x32_bf16 v[176:179], v[84:87], a[32:35], v[176:179]
    v_add_u32 v23, 31744, v22
    v_mfma_f32_16x16x32_bf16 v[180:183], v[84:87], a[36:39], v[180:183]
    ds_read_b64_tr_b16 v[70:71], v15 offset:16896
    v_add_u32 v24, 63488, v22
    v_mfma_f32_16x16x32_bf16 v[184:187], v[84:87], a[40:43], v[184:187]
    v_add_u32 v25, 95232, v22
    ds_read_b64_tr_b16 v[72:73], v14 offset:20480
    v_mfma_f32_16x16x32_bf16 v[188:191], v[84:87], a[44:47], v[188:191]
    v_add_u32 v251, 7168, v250
    s_and_b32 s12, s10, 30
    v_mfma_f32_16x16x32_bf16 v[160:163], v[88:91], a[48:51], v[160:163]
    ds_read_b64_tr_b16 v[74:75], v14 offset:20992
    v_mfma_f32_16x16x32_bf16 v[164:167], v[88:91], a[52:55], v[164:167]
    s_add_u32 s12, s12, s5
    s_lshl_b32 s12, s12, 8
    v_mfma_f32_16x16x32_bf16 v[168:171], v[88:91], a[56:59], v[168:171]
    ds_read_b64_tr_b16 v[76:77], v15 offset:20480
    s_add_u32 s12, s12, 6955008
    v_mfma_f32_16x16x32_bf16 v[172:175], v[88:91], a[60:63], v[172:175]
    v_mov_b32 v240, s12
    ds_read_b64_tr_b16 v[78:79], v15 offset:20992
    v_mfma_f32_16x16x32_bf16 v[176:179], v[92:95], a[48:51], v[176:179]
    s_lshl_b32 s12, s11, 3
    v_mfma_f32_16x16x32_bf16 v[180:183], v[92:95], a[52:55], v[180:183]
    v_mfma_f32_16x16x32_bf16 v[184:187], v[92:95], a[56:59], v[184:187]
    v_mfma_f32_16x16x32_bf16 v[188:191], v[92:95], a[60:63], v[188:191]
    s_waitcnt lgkmcnt(0)
    v_mfma_f32_16x16x32_bf16 v[160:163], v[64:67], a[64:67], v[160:163]
    s_waitcnt vmcnt(0)
    s_barrier
    v_mfma_f32_16x16x32_bf16 v[164:167], v[64:67], a[68:71], v[164:167]
    s_cmp_lg_u32 s3, 0
    s_cbranch_scc1 L_arr_11
    v_lshlrev_b32 v30, 8, v1
    v_mov_b32 v31, 1
    s_mov_b64 exec, 15
    buffer_atomic_add v31, v30, s[80:83], s90 offen sc1
    s_mov_b64 exec, -1
L_arr_11:
    ds_read_b64_tr_b16 v[80:81], v14 offset:24576
    v_mfma_f32_16x16x32_bf16 v[168:171], v[64:67], a[72:75], v[168:171]
    s_and_b32 s13, s2, 7
    s_add_u32 m0, s100, 0
    v_mfma_f32_16x16x32_bf16 v[172:175], v[64:67], a[76:79], v[172:175]
    s_add_u32 s12, s12, s13
    ds_read_b64_tr_b16 v[82:83], v14 offset:25088
    v_mfma_f32_16x16x32_bf16 v[176:179], v[68:71], a[64:67], v[176:179]
    s_lshl_b32 s12, s12, 8
    s_add_u32 s12, s12, 6979584
    v_mfma_f32_16x16x32_bf16 v[180:183], v[68:71], a[68:71], v[180:183]
    ds_read_b64_tr_b16 v[84:85], v15 offset:24576
    v_mov_b32 v241, s12
    v_mfma_f32_16x16x32_bf16 v[184:187], v[68:71], a[72:75], v[184:187]
    v_lshrrev_b32 v228, 2, v2
    ds_read_b64_tr_b16 v[86:87], v15 offset:25088
    v_mfma_f32_16x16x32_bf16 v[188:191], v[68:71], a[76:79], v[188:191]
    v_lshl_add_u32 v228, v3, 2, v228
    v_lshrrev_b32 v229, 1, v228
    v_mfma_f32_16x16x32_bf16 v[160:163], v[72:75], a[80:83], v[160:163]
    ds_read_b64_tr_b16 v[88:89], v14 offset:28672
    s_mov_b32 s101, 0
    v_mfma_f32_16x16x32_bf16 v[164:167], v[72:75], a[84:87], v[164:167]
    v_and_b32 v229, 3, v229
    ds_read_b64_tr_b16 v[90:91], v14 offset:29184
    v_mfma_f32_16x16x32_bf16 v[168:171], v[72:75], a[88:91], v[168:171]
    v_lshlrev_b32 v228, 7, v228
    v_lshl_add_u32 v228, v229, 5, v228
    v_mfma_f32_16x16x32_bf16 v[172:175], v[72:75], a[92:95], v[172:175]
    ds_read_b64_tr_b16 v[92:93], v15 offset:28672
    v_and_b32 v229, 3, v2
    v_mfma_f32_16x16x32_bf16 v[176:179], v[76:79], a[80:83], v[176:179]
    v_lshl_add_u32 v228, v229, 3, v228
    ds_read_b64_tr_b16 v[94:95], v15 offset:29184
    v_mfma_f32_16x16x32_bf16 v[180:183], v[76:79], a[84:87], v[180:183]
    v_add_u32 v227, s99, v228
    v_add_u32 v228, s100, v228
    v_mfma_f32_16x16x32_bf16 v[184:187], v[76:79], a[88:91], v[184:187]
    v_mfma_f32_16x16x32_bf16 v[188:191], v[76:79], a[92:95], v[188:191]
    s_waitcnt lgkmcnt(0)
    v_mfma_f32_16x16x32_bf16 v[160:163], v[80:83], a[96:99], v[160:163]
    ds_read_b64_tr_b16 v[64:65], v14 offset:32768
    v_xor_b32 v229, 32, v228
    v_mfma_f32_16x16x32_bf16 v[164:167], v[80:83], a[100:103], v[164:167]
    buffer_load_dwordx4 v22, s[60:63], s101 offen offset:0 lds
    v_xor_b32 v230, 64, v228
    v_mfma_f32_16x16x32_bf16 v[168:171], v[80:83], a[104:107], v[168:171]
    ds_read_b64_tr_b16 v[66:67], v14 offset:33280
    v_xor_b32 v231, 96, v228
    v_mfma_f32_16x16x32_bf16 v[172:175], v[80:83], a[108:111], v[172:175]
    s_lshl_b32 s12, s10, 16
    ds_read_b64_tr_b16 v[68:69], v15 offset:32768
    v_mfma_f32_16x16x32_bf16 v[176:179], v[84:87], a[96:99], v[176:179]
    s_lshl_b32 s13, s3, 12
    s_add_u32 s12, s12, s13
    v_mfma_f32_16x16x32_bf16 v[180:183], v[84:87], a[100:103], v[180:183]
    ds_read_b64_tr_b16 v[70:71], v15 offset:33280
    s_add_u32 s12, s12, 4194304
    v_mfma_f32_16x16x32_bf16 v[184:187], v[84:87], a[104:107], v[184:187]
    v_add_u32 v232, s12, v4
    ds_read_b64_tr_b16 v[72:73], v14 offset:36864
    v_mfma_f32_16x16x32_bf16 v[188:191], v[84:87], a[108:111], v[188:191]
    buffer_load_dwordx4 v23, s[60:63], s101 offen offset:1024 lds
    v_add_u32 v233, 16384, v232
    v_mfma_f32_16x16x32_bf16 v[160:163], v[88:91], a[112:115], v[160:163]
    ds_read_b64_tr_b16 v[74:75], v14 offset:37376
    s_mul_i32 s13, s11, 176128
    v_mfma_f32_16x16x32_bf16 v[164:167], v[88:91], a[116:119], v[164:167]
    s_mul_i32 s12, s3, 11264
    ds_read_b64_tr_b16 v[76:77], v15 offset:36864
    v_mfma_f32_16x16x32_bf16 v[168:171], v[88:91], a[120:123], v[168:171]
    s_add_u32 s13, s13, s12
    s_add_u32 s13, s13, 2359296
    v_mfma_f32_16x16x32_bf16 v[172:175], v[88:91], a[124:127], v[172:175]
    ds_read_b64_tr_b16 v[78:79], v15 offset:37376
    s_add_u32 s12, s3, 1
    v_mfma_f32_16x16x32_bf16 v[176:179], v[92:95], a[112:115], v[176:179]
    s_and_b32 s12, s12, 3
    v_mfma_f32_16x16x32_bf16 v[180:183], v[92:95], a[116:119], v[180:183]
    v_mfma_f32_16x16x32_bf16 v[184:187], v[92:95], a[120:123], v[184:187]
    v_mfma_f32_16x16x32_bf16 v[188:191], v[92:95], a[124:127], v[188:191]
    s_waitcnt lgkmcnt(0)
    v_mfma_f32_16x16x32_bf16 v[160:163], v[64:67], a[128:131], v[160:163]
    ds_read_b64_tr_b16 v[80:81], v14 offset:40960
    s_lshl_b32 s14, s12, 5
    v_mfma_f32_16x16x32_bf16 v[164:167], v[64:67], a[132:135], v[164:167]
    buffer_load_dwordx4 v24, s[60:63], s101 offen offset:2048 lds
    v_xor_b32 v224, s14, v227
    v_mfma_f32_16x16x32_bf16 v[168:171], v[64:67], a[136:139], v[168:171]
    ds_read_b64_tr_b16 v[82:83], v14 offset:41472
    s_mul_i32 s14, s12, 24576
    v_mfma_f32_16x16x32_bf16 v[172:175], v[64:67], a[140:143], v[172:175]
    s_add_u32 s14, s14, 8192
    ds_read_b64_tr_b16 v[84:85], v15 offset:40960
    v_mfma_f32_16x16x32_bf16 v[176:179], v[68:71], a[128:131], v[176:179]
    v_add_u32 v245, s14, v4
    s_mul_i32 s12, s12, 44032
    v_mfma_f32_16x16x32_bf16 v[180:183], v[68:71], a[132:135], v[180:183]
    ds_read_b64_tr_b16 v[86:87], v15 offset:41472
    s_add_u32 s12, s12, s13
    v_mfma_f32_16x16x32_bf16 v[184:187], v[68:71], a[136:139], v[184:187]
    v_add_u32 v236, s12, v4
    ds_read_b64_tr_b16 v[88:89], v14 offset:45056
    v_mfma_f32_16x16x32_bf16 v[188:191], v[68:71], a[140:143], v[188:191]
    buffer_load_dwordx4 v25, s[60:63], s101 offen offset:3072 lds
    s_add_u32 s12, s3, 2
    v_mfma_f32_16x16x32_bf16 v[160:163], v[72:75], a[144:147], v[160:163]
    ds_read_b64_tr_b16 v[90:91], v14 offset:45568
    s_and_b32 s12, s12, 3
    v_mfma_f32_16x16x32_bf16 v[164:167], v[72:75], a[148:151], v[164:167]
    s_lshl_b32 s14, s12, 5
    ds_read_b64_tr_b16 v[92:93], v15 offset:45056
    v_mfma_f32_16x16x32_bf16 v[168:171], v[72:75], a[152:155], v[168:171]
    v_xor_b32 v225, s14, v227
    s_mul_i32 s14, s12, 24576
    v_mfma_f32_16x16x32_bf16 v[172:175], v[72:75], a[156:159], v[172:175]
    ds_read_b64_tr_b16 v[94:95], v15 offset:45568
    s_add_u32 s14, s14, 4096
    v_mfma_f32_16x16x32_bf16 v[176:179], v[76:79], a[144:147], v[176:179]
    v_add_u32 v246, s14, v4
    v_mfma_f32_16x16x32_bf16 v[180:183], v[76:79], a[148:151], v[180:183]
    v_mfma_f32_16x16x32_bf16 v[184:187], v[76:79], a[152:155], v[184:187]
    v_mfma_f32_16x16x32_bf16 v[188:191], v[76:79], a[156:159], v[188:191]
    s_waitcnt lgkmcnt(0)
    v_mfma_f32_16x16x32_bf16 v[160:163], v[80:83], a[160:163], v[160:163]
    ds_read_b64_tr_b16 v[64:65], v14 offset:49152
    s_mul_i32 s12, s12, 44032
    v_mfma_f32_16x16x32_bf16 v[164:167], v[80:83], a[164:167], v[164:167]
    s_add_u32 m0, s100, 4096
    ds_read_b64_tr_b16 v[66:67], v14 offset:49664
    v_mfma_f32_16x16x32_bf16 v[168:171], v[80:83], a[168:171], v[168:171]
    s_add_u32 s12, s12, s13
    v_add_u32 v237, s12, v4
    v_mfma_f32_16x16x32_bf16 v[172:175], v[80:83], a[172:175], v[172:175]
    ds_read_b64_tr_b16 v[68:69], v15 offset:49152
    s_add_u32 s12, s3, 3
    v_mfma_f32_16x16x32_bf16 v[176:179], v[84:87], a[160:163], v[176:179]
    s_and_b32 s12, s12, 3
    ds_read_b64_tr_b16 v[70:71], v15 offset:49664
    v_mfma_f32_16x16x32_bf16 v[180:183], v[84:87], a[164:167], v[180:183]
    s_lshl_b32 s14, s12, 5
    v_xor_b32 v226, s14, v227
    v_mfma_f32_16x16x32_bf16 v[184:187], v[84:87], a[168:171], v[184:187]
    ds_read_b64_tr_b16 v[72:73], v14 offset:53248
    v_mfma_f32_16x16x32_bf16 v[188:191], v[84:87], a[172:175], v[188:191]
    s_mul_i32 s14, s12, 24576
    s_mov_b32 s101, 131072
    v_mfma_f32_16x16x32_bf16 v[160:163], v[88:91], a[176:179], v[160:163]
    ds_read_b64_tr_b16 v[74:75], v14 offset:53760
    s_add_u32 s14, s14, 0
    v_mfma_f32_16x16x32_bf16 v[164:167], v[88:91], a[180:183], v[164:167]
    v_add_u32 v247, s14, v4
    ds_read_b64_tr_b16 v[76:77], v15 offset:53248
    v_mfma_f32_16x16x32_bf16 v[168:171], v[88:91], a[184:187], v[168:171]
    s_mul_i32 s12, s12, 44032
    s_add_u32 s12, s12, s13
    v_mfma_f32_16x16x32_bf16 v[172:175], v[88:91], a[188:191], v[172:175]
    ds_read_b64_tr_b16 v[78:79], v15 offset:53760
    v_add_u32 v238, s12, v4
    v_mfma_f32_16x16x32_bf16 v[176:179], v[92:95], a[176:179], v[176:179]
    s_add_u32 s12, s3, 4
    v_mfma_f32_16x16x32_bf16 v[180:183], v[92:95], a[180:183], v[180:183]
    v_mfma_f32_16x16x32_bf16 v[184:187], v[92:95], a[184:187], v[184:187]
    v_mfma_f32_16x16x32_bf16 v[188:191], v[92:95], a[188:191], v[188:191]
    s_waitcnt lgkmcnt(0)
    v_mfma_f32_16x16x32_bf16 v[160:163], v[64:67], a[192:195], v[160:163]
    ds_read_b64_tr_b16 v[80:81], v14 offset:57344
    s_and_b32 s12, s12, 3
    v_mfma_f32_16x16x32_bf16 v[164:167], v[64:67], a[196:199], v[164:167]
    buffer_load_dwordx4 v22, s[60:63], s101 offen offset:0 lds
    ds_read_b64_tr_b16 v[82:83], v14 offset:57856
    v_mfma_f32_16x16x32_bf16 v[168:171], v[64:67], a[200:203], v[168:171]
    s_lshl_b32 s14, s12, 5
    v_xor_b32 v227, s14, v227
    v_mfma_f32_16x16x32_bf16 v[172:175], v[64:67], a[204:207], v[172:175]
    ds_read_b64_tr_b16 v[84:85], v15 offset:57344
    s_mul_i32 s14, s12, 24576
    v_mfma_f32_16x16x32_bf16 v[176:179], v[68:71], a[192:195], v[176:179]
    v_add_u32 v244, s100, v4
    ds_read_b64_tr_b16 v[86:87], v15 offset:57856
    v_mfma_f32_16x16x32_bf16 v[180:183], v[68:71], a[196:199], v[180:183]
    s_mul_i32 s12, s12, 44032
    s_add_u32 s12, s12, s13
    v_mfma_f32_16x16x32_bf16 v[184:187], v[68:71], a[200:203], v[184:187]
    ds_read_b64_tr_b16 v[88:89], v14 offset:61440
    v_mfma_f32_16x16x32_bf16 v[188:191], v[68:71], a[204:207], v[188:191]
    v_add_u32 v239, s12, v4
    buffer_load_dwordx4 v23, s[60:63], s101 offen offset:1024 lds
    v_mfma_f32_16x16x32_bf16 v[160:163], v[72:75], a[208:211], v[160:163]
    ds_read_b64_tr_b16 v[90:91], v14 offset:61952
    s_mov_b32 s84, 4096
    v_mfma_f32_16x16x32_bf16 v[164:167], v[72:75], a[212:215], v[164:167]
    s_mov_b32 s85, 8192
    ds_read_b64_tr_b16 v[92:93], v15 offset:61440
    v_mfma_f32_16x16x32_bf16 v[168:171], v[72:75], a[216:219], v[168:171]
    s_mov_b32 s86, 10240
    s_mov_b32 s91, 32768
    v_mfma_f32_16x16x32_bf16 v[172:175], v[72:75], a[220:223], v[172:175]
    ds_read_b64_tr_b16 v[94:95], v15 offset:61952
    s_cmp_eq_u32 s3, 3
    s_cselect_b32 s86, 0xc00000, s86
    v_mfma_f32_16x16x32_bf16 v[176:179], v[76:79], a[208:211], v[176:179]
    s_lshl_b32 s12, s10, 6
    v_mfma_f32_16x16x32_bf16 v[180:183], v[76:79], a[212:215], v[180:183]
    v_mfma_f32_16x16x32_bf16 v[184:187], v[76:79], a[216:219], v[184:187]
    v_mfma_f32_16x16x32_bf16 v[188:191], v[76:79], a[220:223], v[188:191]
    s_waitcnt lgkmcnt(0)
    v_mfma_f32_16x16x32_bf16 v[160:163], v[80:83], a[224:227], v[160:163]
    v_add_u32 v248, s12, v2
    buffer_load_dwordx4 v24, s[60:63], s101 offen offset:2048 lds
    v_mfma_f32_16x16x32_bf16 v[164:167], v[80:83], a[228:231], v[164:167]
    v_lshlrev_b32 v242, 2, v248
    v_mfma_f32_16x16x32_bf16 v[168:171], v[80:83], a[232:235], v[168:171]
    v_add_u32 v242, 6881280, v242
    v_mfma_f32_16x16x32_bf16 v[172:175], v[80:83], a[236:239], v[172:175]
    v_lshlrev_b32 v243, 1, v248
    v_and_b32 v249, 1, v3
    v_mfma_f32_16x16x32_bf16 v[176:179], v[84:87], a[224:227], v[176:179]
    v_lshl_add_u32 v248, v249, 4, v248
    v_mfma_f32_16x16x32_bf16 v[180:183], v[84:87], a[228:231], v[180:183]
    v_lshlrev_b32 v248, 10, v248
    v_mfma_f32_16x16x32_bf16 v[184:187], v[84:87], a[232:235], v[184:187]
    v_lshrrev_b32 v249, 1, v3
    buffer_load_dwordx4 v25, s[60:63], s101 offen offset:3072 lds
    v_mfma_f32_16x16x32_bf16 v[188:191], v[84:87], a[236:239], v[188:191]
    v_lshl_add_u32 v248, v249, 4, v248
    v_mfma_f32_16x16x32_bf16 v[160:163], v[88:91], a[240:243], v[160:163]
    v_add_u32 v249, 32768, v248
    v_mfma_f32_16x16x32_bf16 v[164:167], v[88:91], a[244:247], v[164:167]
    buffer_load_ushort v252, v243, s[64:67], 0 offen offset:0
    buffer_load_ushort v253, v243, s[64:67], 0 offen offset:32
    v_mfma_f32_16x16x32_bf16 v[168:171], v[88:91], a[248:251], v[168:171]
    buffer_load_ushort v254, v243, s[64:67], 0 offen offset:64
    v_mfma_f32_16x16x32_bf16 v[172:175], v[88:91], a[252:255], v[172:175]
    buffer_load_ushort v255, v243, s[64:67], 0 offen offset:96
    v_mfma_f32_16x16x32_bf16 v[176:179], v[92:95], a[240:243], v[176:179]
    buffer_load_dword v31, v8, s[80:83], 0 offen sc1
    v_mfma_f32_16x16x32_bf16 v[180:183], v[92:95], a[244:247], v[180:183]
    v_mfma_f32_16x16x32_bf16 v[184:187], v[92:95], a[248:251], v[184:187]
    v_mfma_f32_16x16x32_bf16 v[188:191], v[92:95], a[252:255], v[188:191]
    s_waitcnt lgkmcnt(0)
    s_barrier
    s_nop 5
    v_pk_mul_f32 v[64:65], v[160:161], s[92:93]
    v_pk_mul_f32 v[66:67], v[162:163], s[92:93]
    v_pk_mul_f32 v[68:69], v[164:165], s[92:93]
    v_pk_mul_f32 v[70:71], v[166:167], s[92:93]
    v_pk_mul_f32 v[72:73], v[168:169], s[92:93]
    v_pk_mul_f32 v[74:75], v[170:171], s[92:93]
    v_pk_mul_f32 v[76:77], v[172:173], s[92:93]
    v_pk_mul_f32 v[78:79], v[174:175], s[92:93]
    v_pk_mul_f32 v[80:81], v[176:177], s[92:93]
    v_pk_mul_f32 v[82:83], v[178:179], s[92:93]
    v_pk_mul_f32 v[84:85], v[180:181], s[92:93]
    v_pk_mul_f32 v[86:87], v[182:183], s[92:93]
    v_pk_mul_f32 v[88:89], v[184:185], s[92:93]
    v_pk_mul_f32 v[90:91], v[186:187], s[92:93]
    v_pk_mul_f32 v[92:93], v[188:189], s[92:93]
    v_pk_mul_f32 v[94:95], v[190:191], s[92:93]
    v_exp_f32 v64, v64 clamp
    v_max_f32 v160, 0, v160
    v_exp_f32 v65, v65 clamp
    v_max_f32 v161, 0, v161
    v_exp_f32 v66, v66 clamp
    v_max_f32 v162, 0, v162
    v_exp_f32 v67, v67 clamp
    v_max_f32 v163, 0, v163
    v_exp_f32 v68, v68 clamp
    v_max_f32 v164, 0, v164
    v_exp_f32 v69, v69 clamp
    v_max_f32 v165, 0, v165
    v_exp_f32 v70, v70 clamp
    v_max_f32 v166, 0, v166
    v_exp_f32 v71, v71 clamp
    v_max_f32 v167, 0, v167
    v_exp_f32 v72, v72 clamp
    v_max_f32 v168, 0, v168
    v_exp_f32 v73, v73 clamp
    v_max_f32 v169, 0, v169
    v_exp_f32 v74, v74 clamp
    v_max_f32 v170, 0, v170
    v_exp_f32 v75, v75 clamp
    v_max_f32 v171, 0, v171
    v_exp_f32 v76, v76 clamp
    v_max_f32 v172, 0, v172
    v_exp_f32 v77, v77 clamp
    v_max_f32 v173, 0, v173
    v_exp_f32 v78, v78 clamp
    v_max_f32 v174, 0, v174
    v_exp_f32 v79, v79 clamp
    v_max_f32 v175, 0, v175
    s_and_b32 s15, s15, 30
    s_lshl_b32 s13, s15, 10
    s_add_u32 s13, s13, 6291456
    s_lshl_b32 s12, s15, 6
    s_add_u32 s12, s12, 6324224
    v_lshlrev_b32 v9, 4, v3
    s_waitcnt vmcnt(0)
    v_cmp_gt_u32 vcc, 16, v31
    s_cbranch_vccz L_kf_12
    s_mov_b32 s14, 0
L_poll_13:
    buffer_load_dword v31, v8, s[80:83], 0 offen sc1
    s_add_u32 s14, s14, 1
    s_waitcnt vmcnt(0)
    v_cmp_gt_u32 vcc, 16, v31
    s_cbranch_vccz L_polled_14
    s_sleep 1
    s_cmp_lt_u32 s14, 0x40000
    s_cbranch_scc1 L_poll_13
L_polled_14:
L_kf_12:
    buffer_load_dwordx4 v[196:199], v9, s[80:83], s12 offen offset:0 sc1
    buffer_load_dword v192, v10, s[80:83], s13 offen offset:0 sc1
    buffer_load_dword v193, v10, s[80:83], s13 offen offset:256 sc1
    buffer_load_dword v194, v10, s[80:83], s13 offen offset:512 sc1
    buffer_load_dword v195, v10, s[80:83], s13 offen offset:768 sc1
    buffer_load_dwordx4 v[204:207], v9, s[80:83], s12 offen offset:64 sc1
    buffer_load_dword v200, v10, s[80:83], s13 offen offset:1024 sc1
    buffer_load_dword v201, v10, s[80:83], s13 offen offset:1280 sc1
    buffer_load_dword v202, v10, s[80:83], s13 offen offset:1536 sc1
    buffer_load_dword v203, v10, s[80:83], s13 offen offset:1792 sc1
    v_exp_f32 v80, v80 clamp
    s_add_u32 m0, s99, 0
    v_max_f32 v176, 0, v176
    v_exp_f32 v81, v81 clamp
    v_max_f32 v177, 0, v177
    v_exp_f32 v82, v82 clamp
    v_max_f32 v178, 0, v178
    s_mov_b32 s101, 0
    v_exp_f32 v83, v83 clamp
    v_max_f32 v179, 0, v179
    v_exp_f32 v84, v84 clamp
    v_max_f32 v180, 0, v180
    v_exp_f32 v85, v85 clamp
    buffer_load_dwordx4 v250, s[48:51], s101 offen offset:0 lds
    v_max_f32 v181, 0, v181
    v_exp_f32 v86, v86 clamp
    v_max_f32 v182, 0, v182
    v_exp_f32 v87, v87 clamp
    v_max_f32 v183, 0, v183
    buffer_load_dwordx4 v251, s[48:51], s101 offen offset:1024 lds
    v_exp_f32 v88, v88 clamp
    v_max_f32 v184, 0, v184
    v_exp_f32 v89, v89 clamp
    v_max_f32 v185, 0, v185
    v_exp_f32 v90, v90 clamp
    s_add_u32 m0, s99, 2048
    v_max_f32 v186, 0, v186
    v_exp_f32 v91, v91 clamp
    v_max_f32 v187, 0, v187
    v_exp_f32 v92, v92 clamp
    v_max_f32 v188, 0, v188
    s_mov_b32 s101, 16384
    v_exp_f32 v93, v93 clamp
    v_max_f32 v189, 0, v189
    v_exp_f32 v94, v94 clamp
    v_max_f32 v190, 0, v190
    v_exp_f32 v95, v95 clamp
    buffer_load_dwordx4 v250, s[48:51], s101 offen offset:0 lds
    v_max_f32 v191, 0, v191
    v_pk_add_f32 v[64:65], v[64:65], s[94:95]
    v_pk_add_f32 v[66:67], v[66:67], s[94:95]
    v_pk_add_f32 v[68:69], v[68:69], s[94:95]
    v_pk_add_f32 v[70:71], v[70:71], s[94:95]
    buffer_load_dwordx4 v251, s[48:51], s101 offen offset:1024 lds
    v_pk_add_f32 v[72:73], v[72:73], s[94:95]
    v_pk_add_f32 v[74:75], v[74:75], s[94:95]
    v_pk_add_f32 v[76:77], v[76:77], s[94:95]
    v_pk_add_f32 v[78:79], v[78:79], s[94:95]
    v_pk_add_f32 v[80:81], v[80:81], s[94:95]
    s_add_u32 m0, s99, 4096
    v_pk_add_f32 v[82:83], v[82:83], s[94:95]
    v_pk_add_f32 v[84:85], v[84:85], s[94:95]
    v_pk_add_f32 v[86:87], v[86:87], s[94:95]
    v_pk_add_f32 v[88:89], v[88:89], s[94:95]
    v_pk_add_f32 v[90:91], v[90:91], s[94:95]
    s_mov_b32 s101, 32768
    v_pk_add_f32 v[92:93], v[92:93], s[94:95]
    v_pk_add_f32 v[94:95], v[94:95], s[94:95]
    v_pk_add_f32 v[64:65], v[64:65], v[160:161]
    v_pk_add_f32 v[66:67], v[66:67], v[162:163]
    v_pk_add_f32 v[68:69], v[68:69], v[164:165]
    buffer_load_dwordx4 v250, s[48:51], s101 offen offset:0 lds
    v_pk_add_f32 v[70:71], v[70:71], v[166:167]
    v_pk_add_f32 v[72:73], v[72:73], v[168:169]
    v_pk_add_f32 v[74:75], v[74:75], v[170:171]
    v_pk_add_f32 v[76:77], v[76:77], v[172:173]
    v_pk_add_f32 v[78:79], v[78:79], v[174:175]
    buffer_load_dwordx4 v251, s[48:51], s101 offen offset:1024 lds
    v_pk_add_f32 v[80:81], v[80:81], v[176:177]
    v_pk_add_f32 v[82:83], v[82:83], v[178:179]
    v_pk_add_f32 v[84:85], v[84:85], v[180:181]
    v_pk_add_f32 v[86:87], v[86:87], v[182:183]
    v_pk_add_f32 v[88:89], v[88:89], v[184:185]
    s_add_u32 m0, s99, 6144
    v_pk_add_f32 v[90:91], v[90:91], v[186:187]
    v_pk_add_f32 v[92:93], v[92:93], v[188:189]
    v_pk_add_f32 v[94:95], v[94:95], v[190:191]
    v_cvt_pk_bf16_f32 v128, v64, v65
    v_cvt_pk_bf16_f32 v129, v66, v67
    s_mov_b32 s101, 49152
    v_cvt_pk_bf16_f32 v130, v68, v69
    v_cvt_pk_bf16_f32 v131, v70, v71
    v_cvt_pk_bf16_f32 v132, v72, v73
    v_cvt_pk_bf16_f32 v133, v74, v75
    v_cvt_pk_bf16_f32 v134, v76, v77
    buffer_load_dwordx4 v250, s[48:51], s101 offen offset:0 lds
    v_cvt_pk_bf16_f32 v135, v78, v79
    v_cvt_pk_bf16_f32 v136, v80, v81
    v_cvt_pk_bf16_f32 v137, v82, v83
    v_cvt_pk_bf16_f32 v138, v84, v85
    v_cvt_pk_bf16_f32 v139, v86, v87
    buffer_load_dwordx4 v251, s[48:51], s101 offen offset:1024 lds
    v_cvt_pk_bf16_f32 v140, v88, v89
    v_cvt_pk_bf16_f32 v141, v90, v91
    v_cvt_pk_bf16_f32 v142, v92, v93
    v_cvt_pk_bf16_f32 v143, v94, v95
    s_lshl_b32 s15, s8, 3
    s_lshl_b32 s12, s96, 2
    s_add_u32 s15, s15, s12
    s_lshl_b32 s15, s15, 4
    s_lshl_b32 s12, s9, 1
    s_add_u32 s15, s15, s12
    s_add_u32 s15, s15, s97
    s_lshl_b32 s15, s15, 10
    s_add_u32 s15, s15, 4194304
    s_waitcnt vmcnt(8)
    v_cvt_pk_bf16_f32 v40, v192, v193
    v_cvt_pk_bf16_f32 v41, v194, v195
    v_cvt_pk_bf16_f32 v42, v196, v197
    v_cvt_pk_bf16_f32 v43, v198, v199
    v_cvt_pk_bf16_f32 v44, v200, v201
    v_cvt_pk_bf16_f32 v45, v202, v203
    v_cvt_pk_bf16_f32 v46, v204, v205
    v_cvt_pk_bf16_f32 v47, v206, v207
    s_nop 1
    v_mfma_f32_16x16x16_bf16 v[192:195], v[42:43], v[128:129], 0
    v_mfma_f32_16x16x16_bf16 v[196:199], v[42:43], v[130:131], 0
    v_mfma_f32_16x16x16_bf16 v[200:203], v[42:43], v[132:133], 0
    v_mfma_f32_16x16x16_bf16 v[204:207], v[42:43], v[134:135], 0
    v_mfma_f32_16x16x16_bf16 v[208:211], v[46:47], v[136:137], 0
    v_mfma_f32_16x16x16_bf16 v[212:215], v[46:47], v[138:139], 0
    v_mfma_f32_16x16x16_bf16 v[216:219], v[46:47], v[140:141], 0
    v_mfma_f32_16x16x16_bf16 v[220:223], v[46:47], v[142:143], 0
    v_mfma_f32_16x16x16_bf16 v[160:163], v[40:41], v[128:129], 0
    v_mfma_f32_16x16x16_bf16 v[164:167], v[40:41], v[130:131], 0
    v_mfma_f32_16x16x16_bf16 v[168:171], v[40:41], v[132:133], 0
    v_mfma_f32_16x16x16_bf16 v[172:175], v[40:41], v[134:135], 0
    v_mfma_f32_16x16x16_bf16 v[176:179], v[44:45], v[136:137], 0
    v_mfma_f32_16x16x16_bf16 v[180:183], v[44:45], v[138:139], 0
    v_mfma_f32_16x16x16_bf16 v[184:187], v[44:45], v[140:141], 0
    v_mfma_f32_16x16x16_bf16 v[188:191], v[44:45], v[142:143], 0
    s_nop 0
    v_add_f32 v192, s94, v192
    v_add_f32 v196, s94, v196
    v_add_f32 v200, s94, v200
    v_add_f32 v204, s94, v204
    v_add_f32 v208, s94, v208
    v_add_f32 v212, s94, v212
    v_add_f32 v216, s94, v216
    v_add_f32 v220, s94, v220
    v_rcp_f32 v192, v192
    v_rcp_f32 v196, v196
    v_rcp_f32 v200, v200
    v_rcp_f32 v204, v204
    v_rcp_f32 v208, v208
    v_rcp_f32 v212, v212
    v_rcp_f32 v216, v216
    v_rcp_f32 v220, v220
    v_pk_mul_f32 v[160:161], v[160:161], v[192:193] op_sel_hi:[1,0]
    v_pk_mul_f32 v[162:163], v[162:163], v[192:193] op_sel_hi:[1,0]
    v_pk_mul_f32 v[164:165], v[164:165], v[196:197] op_sel_hi:[1,0]
    v_pk_mul_f32 v[166:167], v[166:167], v[196:197] op_sel_hi:[1,0]
    v_pk_mul_f32 v[168:169], v[168:169], v[200:201] op_sel_hi:[1,0]
    v_pk_mul_f32 v[170:171], v[170:171], v[200:201] op_sel_hi:[1,0]
    v_pk_mul_f32 v[172:173], v[172:173], v[204:205] op_sel_hi:[1,0]
    v_pk_mul_f32 v[174:175], v[174:175], v[204:205] op_sel_hi:[1,0]
    v_pk_mul_f32 v[176:177], v[176:177], v[208:209] op_sel_hi:[1,0]
    v_pk_mul_f32 v[178:179], v[178:179], v[208:209] op_sel_hi:[1,0]
    v_pk_mul_f32 v[180:181], v[180:181], v[212:213] op_sel_hi:[1,0]
    v_pk_mul_f32 v[182:183], v[182:183], v[212:213] op_sel_hi:[1,0]
    v_pk_mul_f32 v[184:185], v[184:185], v[216:217] op_sel_hi:[1,0]
    v_pk_mul_f32 v[186:187], v[186:187], v[216:217] op_sel_hi:[1,0]
    v_pk_mul_f32 v[188:189], v[188:189], v[220:221] op_sel_hi:[1,0]
    v_pk_mul_f32 v[190:191], v[190:191], v[220:221] op_sel_hi:[1,0]
    v_cvt_pk_bf16_f32 v64, v160, v161
    v_cvt_pk_bf16_f32 v65, v162, v163
    v_cvt_pk_bf16_f32 v66, v176, v177
    v_cvt_pk_bf16_f32 v67, v178, v179
    s_add_u32 s12, s15, 0
    buffer_store_dwordx4 v[64:67], v4, s[80:83], s12 offen sc1
    v_cvt_pk_bf16_f32 v68, v164, v165
    v_cvt_pk_bf16_f32 v69, v166, v167
    v_cvt_pk_bf16_f32 v70, v180, v181
    v_cvt_pk_bf16_f32 v71, v182, v183
    s_add_u32 s12, s15, 16384
    buffer_store_dwordx4 v[68:71], v4, s[80:83], s12 offen sc1
    v_cvt_pk_bf16_f32 v72, v168, v169
    v_cvt_pk_bf16_f32 v73, v170, v171
    v_cvt_pk_bf16_f32 v74, v184, v185
    v_cvt_pk_bf16_f32 v75, v186, v187
    s_add_u32 s12, s15, 32768
    buffer_store_dwordx4 v[72:75], v4, s[80:83], s12 offen sc1
    v_cvt_pk_bf16_f32 v76, v172, v173
    v_cvt_pk_bf16_f32 v77, v174, v175
    v_cvt_pk_bf16_f32 v78, v188, v189
    v_cvt_pk_bf16_f32 v79, v190, v191
    s_add_u32 s12, s15, 49152
    buffer_store_dwordx4 v[76:79], v4, s[80:83], s12 offen sc1
    s_add_u32 m0, s99, 8192
    s_mov_b32 s101, 65536
    buffer_load_dwordx4 v250, s[48:51], s101 offen offset:0 lds
    buffer_load_dwordx4 v251, s[48:51], s101 offen offset:1024 lds
    s_add_u32 m0, s99, 10240
    s_mov_b32 s101, 81920
    buffer_load_dwordx4 v250, s[48:51], s101 offen offset:0 lds
    buffer_load_dwordx4 v251, s[48:51], s101 offen offset:1024 lds
    s_add_u32 m0, s99, 12288
    s_mov_b32 s101, 98304
    buffer_load_dwordx4 v250, s[48:51], s101 offen offset:0 lds
    buffer_load_dwordx4 v251, s[48:51], s101 offen offset:1024 lds
    s_add_u32 m0, s99, 14336
    s_mov_b32 s101, 114688
    buffer_load_dwordx4 v250, s[48:51], s101 offen offset:0 lds
    buffer_load_dwordx4 v251, s[48:51], s101 offen offset:1024 lds
    s_waitcnt vmcnt(8)
    s_barrier
    s_lshl_b32 s12, s8, 9
    s_add_u32 s12, s12, 6955008
    s_cmp_lg_u32 s3, 0
    s_cbranch_scc1 L_arr_15
    v_lshlrev_b32 v30, 8, v1
    v_mov_b32 v31, 1
    s_mov_b64 exec, 3
    buffer_atomic_add v31, v30, s[80:83], s12 offen sc1
    s_mov_b64 exec, -1
L_arr_15:
    s_add_u32 m0, s100, 8192
    s_mov_b32 s101, 262144
    buffer_load_dwordx4 v22, s[60:63], s101 offen offset:0 lds
    buffer_load_dwordx4 v23, s[60:63], s101 offen offset:1024 lds
    buffer_load_dwordx4 v24, s[60:63], s101 offen offset:2048 lds
    buffer_load_dwordx4 v25, s[60:63], s101 offen offset:3072 lds
    s_add_u32 m0, s100, 12288
    s_mov_b32 s101, 393216
    buffer_load_dwordx4 v22, s[60:63], s101 offen offset:0 lds
    buffer_load_dwordx4 v23, s[60:63], s101 offen offset:1024 lds
    buffer_load_dwordx4 v24, s[60:63], s101 offen offset:2048 lds
    buffer_load_dwordx4 v25, s[60:63], s101 offen offset:3072 lds
    s_add_u32 m0, s100, 16384
    s_mov_b32 s101, 524288
    buffer_load_dwordx4 v22, s[60:63], s101 offen offset:0 lds
    buffer_load_dwordx4 v23, s[60:63], s101 offen offset:1024 lds
    buffer_load_dwordx4 v24, s[60:63], s101 offen offset:2048 lds
    buffer_load_dwordx4 v25, s[60:63], s101 offen offset:3072 lds
    s_add_u32 m0, s100, 20480
    s_mov_b32 s101, 655360
    buffer_load_dwordx4 v22, s[60:63], s101 offen offset:0 lds
    buffer_load_dwordx4 v23, s[60:63], s101 offen offset:1024 lds
    buffer_load_dwordx4 v24, s[60:63], s101 offen offset:2048 lds
    buffer_load_dwordx4 v25, s[60:63], s101 offen offset:3072 lds
    v_mov_b32 v29, 0
    s_branch L_p3
L_urole:
    s_and_b32 s9, s6, 3
    s_lshl_b32 s9, s9, 1
    s_add_u32 s9, s9, s5
    s_and_b32 s97, s9, 1
    s_lshl_b32 s97, s97, 2
    s_add_u32 s97, s97, s3
    v_lshrrev_b32 v12, 2, v1
    v_and_b32 v13, 3, v1
    s_mul_i32 s13, s97, 704512
    s_mul_i32 s12, s8, 192
    s_add_u32 s13, s13, s12
    v_add_u32 v14, 0, v12
    v_mul_u32_u24 v15, 43, v14
    v_lshrrev_b32 v15, 7, v15
    v_mul_u32_u24 v16, 3, v15
    v_sub_u32 v14, v14, v16
    v_lshrrev_b32 v16, 2, v15
    v_and_b32 v16, 2, v16
    v_xor_b32 v16, v16, v13
    v_lshlrev_b32 v16, 4, v16
    v_lshl_add_u32 v16, v14, 6, v16
    v_mul_u32_u24 v15, 2752, v15
    v_add3_u32 v6, v15, v16, s13
    v_add_u32 v9, 44032, v6
    v_add_u32 v14, 16, v12
    v_mul_u32_u24 v15, 43, v14
    v_lshrrev_b32 v15, 7, v15
    v_mul_u32_u24 v16, 3, v15
    v_sub_u32 v14, v14, v16
    v_lshrrev_b32 v16, 2, v15
    v_and_b32 v16, 2, v16
    v_xor_b32 v16, v16, v13
    v_lshlrev_b32 v16, 4, v16
    v_lshl_add_u32 v16, v14, 6, v16
    v_mul_u32_u24 v15, 2752, v15
    v_add3_u32 v7, v15, v16, s13
    v_subrev_u32 v7, 1024, v7
    v_add_u32 v10, 44032, v7
    v_add_u32 v14, 32, v12
    v_mul_u32_u24 v15, 43, v14
    v_lshrrev_b32 v15, 7, v15
    v_mul_u32_u24 v16, 3, v15
    v_sub_u32 v14, v14, v16
    v_lshrrev_b32 v16, 2, v15
    v_and_b32 v16, 2, v16
    v_xor_b32 v16, v16, v13
    v_lshlrev_b32 v16, 4, v16
    v_lshl_add_u32 v16, v14, 6, v16
    v_mul_u32_u24 v15, 2752, v15
    v_add3_u32 v8, v15, v16, s13
    v_subrev_u32 v8, 2048, v8
    v_add_u32 v11, 44032, v8
    s_and_b32 s90, s6, 3
    s_mul_i32 s88, s90, 176128
    s_waitcnt lgkmcnt(0)
    s_mov_b32 s52, s24
    s_mov_b32 s53, s25
    s_mov_b32 s54, 5636096
    s_mov_b32 s55, 0x20000
    s_cmp_eq_u32 s8, 15
    s_cbranch_scc1 L_spare
    s_add_u32 m0, s7, 0
    s_nop 0
    buffer_load_dwordx4 v6, s[52:55], s88 offen offset:0 lds
    buffer_load_dwordx4 v7, s[52:55], s88 offen offset:1024 lds
    buffer_load_dwordx4 v8, s[52:55], s88 offen offset:2048 lds
    s_add_u32 m0, s7, 3072
    s_nop 0
    buffer_load_dwordx4 v9, s[52:55], s88 offen offset:0 lds
    buffer_load_dwordx4 v10, s[52:55], s88 offen offset:1024 lds
    buffer_load_dwordx4 v11, s[52:55], s88 offen offset:2048 lds
    s_add_u32 s88, s88, 88064
    s_mov_b32 s40, s16
    s_mov_b32 s41, s17
    s_mov_b32 s42, 2097152
    s_mov_b32 s43, 0x20000
    s_mov_b32 s44, s18
    s_mov_b32 s45, s19
    s_mov_b32 s46, 1572864
    s_mov_b32 s47, 0x20000
    s_and_b32 s12, s6, 15
    s_lshl_b32 s12, s12, 2
    s_add_u32 s12, s12, s3
    s_lshr_b32 s13, s12, 4
    s_lshl_b32 s13, s13, 17
    s_and_b32 s12, s12, 15
    s_lshl_b32 s12, s12, 12
    s_add_u32 s12, s12, s13
    s_lshl_b32 s13, s4, 19
    s_add_u32 s12, s12, s13
    s_xor_b32 s13, s5, 1
    s_lshl_b32 s13, s13, 16
    s_add_u32 s12, s12, s13
    v_lshlrev_b32 v117, 7, v1
    s_mov_b64 exec, 0xffffffff
    buffer_load_dword v157, v117, s[40:43], s12 offen
    s_mov_b64 exec, -1
    s_lshl_b32 s12, s6, 2
    s_add_u32 s12, s12, s3
    v_lshrrev_b32 v116, 3, v1
    v_mul_u32_u24 v116, 3072, v116
    v_bfe_u32 v117, v1, 2, 1
    v_lshl_add_u32 v116, v117, 10, v116
    v_and_b32 v117, 3, v1
    v_lshl_add_u32 v116, v117, 7, v116
    s_mul_i32 s13, s12, 12288
    s_lshl_b32 s14, s5, 9
    s_add_u32 s13, s13, s14
    s_mov_b64 exec, 0xffffffff
    buffer_load_dword v157, v116, s[44:47], s13 offen offset:1024
    s_mov_b64 exec, -1
    s_add_u32 m0, s7, 6144
    s_nop 0
    buffer_load_dwordx4 v6, s[52:55], s88 offen offset:0 lds
    buffer_load_dwordx4 v7, s[52:55], s88 offen offset:1024 lds
    buffer_load_dwordx4 v8, s[52:55], s88 offen offset:2048 lds
    s_add_u32 m0, s7, 9216
    s_nop 0
    buffer_load_dwordx4 v9, s[52:55], s88 offen offset:0 lds
    buffer_load_dwordx4 v10, s[52:55], s88 offen offset:1024 lds
    buffer_load_dwordx4 v11, s[52:55], s88 offen offset:2048 lds
    s_xor_b32 s88, s90, 1
    s_mul_i32 s88, s88, 176128
    s_mov_b32 s56, s26
    s_mov_b32 s57, s27
    s_mov_b32 s58, 2752
    s_mov_b32 s59, 0x20000
    s_mul_i32 s12, s8, 192
    v_lshlrev_b32 v30, 3, v3
    buffer_load_dwordx2 v[208:209], v30, s[56:59], s12 offen offset:0
    buffer_load_dwordx2 v[210:211], v30, s[56:59], s12 offen offset:32
    buffer_load_dwordx2 v[212:213], v30, s[56:59], s12 offen offset:64
    buffer_load_dwordx2 v[214:215], v30, s[56:59], s12 offen offset:96
    buffer_load_dwordx2 v[216:217], v30, s[56:59], s12 offen offset:128
    buffer_load_dwordx2 v[218:219], v30, s[56:59], s12 offen offset:160
    s_mov_b32 s80, s38
    s_mov_b32 s81, s39
    s_mov_b32 s82, 12582912
    s_mov_b32 s83, 0x20000
    s_mov_b32 s76, s36
    s_mov_b32 s77, s37
    s_mov_b32 s78, 256
    s_mov_b32 s79, 0x20000
    s_mov_b32 s48, s20
    s_mov_b32 s49, s21
    s_mov_b32 s50, 524288
    s_mov_b32 s51, 0x20000
    s_mov_b32 s60, s28
    s_mov_b32 s61, s29
    s_mov_b32 s62, 5636096
    s_mov_b32 s63, 0x20000
    s_mov_b32 s64, s30
    s_mov_b32 s65, s31
    s_mov_b32 s66, 4096
    s_mov_b32 s67, 0x20000
    s_mov_b32 s72, s34
    s_mov_b32 s73, s35
    s_mov_b32 s74, 2097152
    s_mov_b32 s75, 0x20000
    v_lshrrev_b32 v16, 2, v2
    v_lshl_add_u32 v16, v3, 3, v16
    v_mul_u32_u24 v16, 192, v16
    v_and_b32 v12, 3, v2
    v_lshl_add_u32 v16, v12, 3, v16
    v_add_u32 v16, s7, v16
    v_and_b32 v12, 1, v3
    v_lshlrev_b32 v12, 5, v12
    v_xor_b32 v13, 32, v12
    v_add_u32 v17, v16, v13
    v_add_u32 v16, v16, v12
    s_and_b32 s13, s9, 6
    s_mul_i32 s13, s13, 262144
    s_lshl_b32 s12, s97, 13
    s_add_u32 s13, s13, s12
    s_add_u32 s12, s3, 3
    s_and_b32 s12, s12, 3
    s_mul_i32 s12, s12, 65536
    s_add_u32 s12, s12, s13
    v_add_u32 v12, s12, v4
    s_add_u32 s12, s3, 2
    s_and_b32 s12, s12, 3
    s_mul_i32 s12, s12, 65536
    s_add_u32 s12, s12, s13
    v_add_u32 v13, s12, v4
    s_add_u32 s12, s3, 1
    s_and_b32 s12, s12, 3
    s_mul_i32 s12, s12, 65536
    s_add_u32 s12, s12, s13
    v_add_u32 v14, s12, v4
    s_add_u32 s12, s3, 0
    s_and_b32 s12, s12, 3
    s_mul_i32 s12, s12, 65536
    s_add_u32 s12, s12, s13
    v_add_u32 v15, s12, v4
    s_and_b32 s12, s9, 1
    s_xor_b32 s12, s12, 1
    s_lshl_b32 s12, s12, 18
    s_xor_b32 s92, s90, 0
    s_lshl_b32 s92, s92, 11
    s_add_u32 s92, s92, s12
    s_xor_b32 s93, s90, 1
    s_lshl_b32 s93, s93, 11
    s_add_u32 s93, s93, s12
    s_xor_b32 s94, s90, 2
    s_lshl_b32 s94, s94, 11
    s_add_u32 s94, s94, s12
    s_xor_b32 s95, s90, 3
    s_lshl_b32 s95, s95, 11
    s_add_u32 s95, s95, s12
    s_add_u32 s100, s7, 16384
    s_mov_b32 s99, s7
    v_lshrrev_b32 v30, 3, v1
    v_and_b32 v31, 7, v1
    v_and_b32 v22, 6, v30
    v_xor_b32 v31, v31, v22
    v_lshlrev_b32 v31, 4, v31
    v_lshl_add_u32 v22, v30, 12, v31
    v_lshl_add_u32 v250, v30, 10, v31
    s_lshl_b32 s13, s11, 7
    s_lshl_b32 s87, s3, 5
    s_add_u32 s87, s87, s13
    s_lshl_b32 s12, s3, 17
    s_add_u32 s12, s12, s13
    v_add_u32 v250, s12, v250
    s_mul_i32 s12, s3, 1441792
    s_lshl_b32 s13, s10, 7
    s_add_u32 s12, s12, s13
    v_add_u32 v22, s12, v22
    v_add_u32 v23, 31744, v22
    v_add_u32 v24, 63488, v22
    v_add_u32 v25, 95232, v22
    v_add_u32 v251, 7168, v250
    s_and_b32 s12, s10, 30
    s_add_u32 s12, s12, s5
    s_lshl_b32 s12, s12, 8
    s_add_u32 s12, s12, 6955008
    v_mov_b32 v240, s12
    s_lshl_b32 s12, s11, 3
    s_and_b32 s13, s2, 7
    s_add_u32 s12, s12, s13
    s_lshl_b32 s12, s12, 8
    s_add_u32 s12, s12, 6979584
    v_mov_b32 v241, s12
    v_lshrrev_b32 v228, 2, v2
    v_lshl_add_u32 v228, v3, 2, v228
    v_lshrrev_b32 v229, 1, v228
    v_and_b32 v229, 3, v229
    v_lshlrev_b32 v228, 7, v228
    v_lshl_add_u32 v228, v229, 5, v228
    v_and_b32 v229, 3, v2
    v_lshl_add_u32 v228, v229, 3, v228
    v_add_u32 v227, s99, v228
    v_add_u32 v228, s100, v228
    v_xor_b32 v229, 32, v228
    v_xor_b32 v230, 64, v228
    v_xor_b32 v231, 96, v228
    s_lshl_b32 s12, s10, 16
    s_lshl_b32 s13, s3, 12
    s_add_u32 s12, s12, s13
    s_add_u32 s12, s12, 4194304
    v_add_u32 v232, s12, v4
    v_add_u32 v233, 16384, v232
    s_mul_i32 s13, s11, 176128
    s_mul_i32 s12, s3, 11264
    s_add_u32 s13, s13, s12
    s_add_u32 s13, s13, 2359296
    s_add_u32 s12, s3, 1
    s_and_b32 s12, s12, 3
    s_lshl_b32 s14, s12, 5
    v_xor_b32 v224, s14, v227
    s_mul_i32 s14, s12, 40960
    s_add_u32 s14, s14, 24576
    v_add_u32 v245, s14, v4
    s_mul_i32 s12, s12, 44032
    s_add_u32 s12, s12, s13
    v_add_u32 v236, s12, v4
    s_add_u32 s12, s3, 2
    s_and_b32 s12, s12, 3
    s_lshl_b32 s14, s12, 5
    v_xor_b32 v225, s14, v227
    s_mul_i32 s14, s12, 40960
    s_add_u32 s14, s14, 20480
    v_add_u32 v246, s14, v4
    s_mul_i32 s12, s12, 44032
    s_add_u32 s12, s12, s13
    v_add_u32 v237, s12, v4
    s_add_u32 s12, s3, 3
    s_and_b32 s12, s12, 3
    s_lshl_b32 s14, s12, 5
    v_xor_b32 v226, s14, v227
    s_mul_i32 s14, s12, 40960
    s_add_u32 s14, s14, 16384
    v_add_u32 v247, s14, v4
    s_mul_i32 s12, s12, 44032
    s_add_u32 s12, s12, s13
    v_add_u32 v238, s12, v4
    s_add_u32 s12, s3, 4
    s_and_b32 s12, s12, 3
    s_lshl_b32 s14, s12, 5
    v_xor_b32 v227, s14, v227
    s_mul_i32 s14, s12, 40960
    v_add_u32 v244, s100, v4
    s_mul_i32 s12, s12, 44032
    s_add_u32 s12, s12, s13
    v_add_u32 v239, s12, v4
    s_mov_b32 s84, 4096
    s_mov_b32 s85, 8192
    s_mov_b32 s86, 10240
    s_mov_b32 s91, 32768
    s_cmp_eq_u32 s3, 3
    s_cselect_b32 s86, 0xc00000, s86
    s_lshl_b32 s12, s10, 6
    v_add_u32 v248, s12, v2
    v_lshlrev_b32 v242, 2, v248
    v_add_u32 v242, 6881280, v242
    v_lshlrev_b32 v243, 1, v248
    v_and_b32 v249, 1, v3
    v_lshl_add_u32 v248, v249, 4, v248
    v_lshlrev_b32 v248, 10, v248
    v_lshrrev_b32 v249, 1, v3
    v_lshl_add_u32 v248, v249, 4, v248
    v_add_u32 v249, 32768, v248
    buffer_load_ushort v252, v243, s[64:67], 0 offen offset:0
    buffer_load_ushort v253, v243, s[64:67], 0 offen offset:32
    buffer_load_ushort v254, v243, s[64:67], 0 offen offset:64
    buffer_load_ushort v255, v243, s[64:67], 0 offen offset:96
    s_add_u32 s12, s7, 34816
    v_add_u32 v26, s12, v4
    s_add_u32 s12, s3, 3
    s_and_b32 s12, s12, 3
    s_mul_i32 s12, s12, 40960
    s_add_u32 s12, s12, 34816
    v_add_u32 v27, s12, v4
    s_and_b32 s12, s2, 7
    s_lshr_b32 s13, s97, 1
    s_lshl_b32 s13, s13, 3
    s_add_u32 s12, s12, s13
    s_lshl_b32 s12, s12, 8
    s_add_u32 s12, s12, 6971392
    v_mov_b32 v18, s12
    s_lshl_b32 s12, s8, 3
    s_add_u32 s12, s12, s9
    s_lshl_b32 s13, s12, 8
    s_lshl_b32 s14, s3, 6
    s_add_u32 s13, s13, s14
    s_add_u32 s13, s13, 7012352
    v_mov_b32 v235, s13
    s_lshl_b32 s12, s12, 2
    s_add_u32 s12, s12, s3
    s_mul_i32 s12, s12, 6144
    s_add_u32 s12, s12, 8388608
    v_add_u32 v234, s12, v4
    s_lshl_b32 s12, s8, 3
    s_add_u32 s12, s12, s9
    s_xor_b32 s12, s12, 1
    s_lshl_b32 s13, s12, 8
    s_lshl_b32 s14, s3, 6
    s_add_u32 s13, s13, s14
    s_add_u32 s13, s13, 7012352
    v_mov_b32 v21, s13
    s_lshl_b32 s12, s12, 2
    s_add_u32 s12, s12, s3
    s_mul_i32 s12, s12, 6144
    s_add_u32 s12, s12, 8388608
    v_add_u32 v20, s12, v4
    s_lshl_b32 s15, s9, 2
    s_add_u32 s15, s15, s3
    s_mul_i32 s15, s15, 43
    s_mul_i32 s13, s8, 3
    s_add_u32 s15, s15, s13
    s_lshl_b32 s15, s15, 10
    s_add_u32 s15, s15, 2359296
    s_cmp_eq_u32 s8, 14
    s_cselect_b32 s13, 0x7ff00000, 0
    v_or_b32 v19, s13, v4
    s_barrier
    s_add_u32 m0, s7, 12288
    s_nop 0
    buffer_load_dwordx4 v6, s[52:55], s88 offen offset:0 lds
    buffer_load_dwordx4 v7, s[52:55], s88 offen offset:1024 lds
    buffer_load_dwordx4 v8, s[52:55], s88 offen offset:2048 lds
    s_add_u32 m0, s7, 15360
    s_nop 0
    buffer_load_dwordx4 v9, s[52:55], s88 offen offset:0 lds
    buffer_load_dwordx4 v10, s[52:55], s88 offen offset:1024 lds
    buffer_load_dwordx4 v11, s[52:55], s88 offen offset:2048 lds
    s_add_u32 s88, s88, 88064
    s_add_u32 m0, s7, 18432
    s_nop 0
    buffer_load_dwordx4 v6, s[52:55], s88 offen offset:0 lds
    buffer_load_dwordx4 v7, s[52:55], s88 offen offset:1024 lds
    buffer_load_dwordx4 v8, s[52:55], s88 offen offset:2048 lds
    s_add_u32 m0, s7, 21504
    s_nop 0
    buffer_load_dwordx4 v9, s[52:55], s88 offen offset:0 lds
    buffer_load_dwordx4 v10, s[52:55], s88 offen offset:1024 lds
    buffer_load_dwordx4 v11, s[52:55], s88 offen offset:2048 lds
    s_xor_b32 s88, s90, 2
    s_mul_i32 s88, s88, 176128
    buffer_load_dword v31, v5, s[76:79], 0 offen sc1
    s_barrier
    s_add_u32 m0, s7, 24576
    s_nop 0
    buffer_load_dwordx4 v6, s[52:55], s88 offen offset:0 lds
    buffer_load_dwordx4 v7, s[52:55], s88 offen offset:1024 lds
    buffer_load_dwordx4 v8, s[52:55], s88 offen offset:2048 lds
    s_add_u32 m0, s7, 27648
    s_nop 0
    buffer_load_dwordx4 v9, s[52:55], s88 offen offset:0 lds
    buffer_load_dwordx4 v10, s[52:55], s88 offen offset:1024 lds
    buffer_load_dwordx4 v11, s[52:55], s88 offen offset:2048 lds
    s_add_u32 s88, s88, 88064
    s_add_u32 m0, s7, 30720
    s_nop 0
    buffer_load_dwordx4 v6, s[52:55], s88 offen offset:0 lds
    buffer_load_dwordx4 v7, s[52:55], s88 offen offset:1024 lds
    buffer_load_dwordx4 v8, s[52:55], s88 offen offset:2048 lds
    s_add_u32 m0, s7, 33792
    s_nop 0
    buffer_load_dwordx4 v9, s[52:55], s88 offen offset:0 lds
    buffer_load_dwordx4 v10, s[52:55], s88 offen offset:1024 lds
    buffer_load_dwordx4 v11, s[52:55], s88 offen offset:2048 lds
    s_xor_b32 s88, s90, 3
    s_mul_i32 s88, s88, 176128
    s_waitcnt vmcnt(43)
    ds_read_b64_tr_b16 a[64:65], v16 offset:0
    ds_read_b64_tr_b16 a[66:67], v16 offset:768
    ds_read_b64_tr_b16 a[68:69], v17 offset:0
    ds_read_b64_tr_b16 a[70:71], v17 offset:768
    ds_read_b64_tr_b16 a[72:73], v16 offset:64
    ds_read_b64_tr_b16 a[74:75], v16 offset:832
    ds_read_b64_tr_b16 a[76:77], v17 offset:64
    ds_read_b64_tr_b16 a[78:79], v17 offset:832
    ds_read_b64_tr_b16 a[80:81], v16 offset:128
    ds_read_b64_tr_b16 a[82:83], v16 offset:896
    ds_read_b64_tr_b16 a[84:85], v17 offset:128
    ds_read_b64_tr_b16 a[86:87], v17 offset:896
    s_waitcnt lgkmcnt(0)
    s_add_u32 m0, s7, 0
    s_nop 0
    buffer_load_dwordx4 v6, s[52:55], s88 offen offset:0 lds
    buffer_load_dwordx4 v7, s[52:55], s88 offen offset:1024 lds
    buffer_load_dwordx4 v8, s[52:55], s88 offen offset:2048 lds
    s_add_u32 m0, s7, 3072
    s_nop 0
    buffer_load_dwordx4 v9, s[52:55], s88 offen offset:0 lds
    buffer_load_dwordx4 v10, s[52:55], s88 offen offset:1024 lds
    buffer_load_dwordx4 v11, s[52:55], s88 offen offset:2048 lds
    s_add_u32 s88, s88, 88064
    s_waitcnt vmcnt(41)
    ds_read_b64_tr_b16 a[88:89], v16 offset:6144
    ds_read_b64_tr_b16 a[90:91], v16 offset:6912
    ds_read_b64_tr_b16 a[92:93], v17 offset:6144
    ds_read_b64_tr_b16 a[94:95], v17 offset:6912
    ds_read_b64_tr_b16 a[96:97], v16 offset:6208
    ds_read_b64_tr_b16 a[98:99], v16 offset:6976
    ds_read_b64_tr_b16 a[100:101], v17 offset:6208
    ds_read_b64_tr_b16 a[102:103], v17 offset:6976
    ds_read_b64_tr_b16 a[104:105], v16 offset:6272
    ds_read_b64_tr_b16 a[106:107], v16 offset:7040
    ds_read_b64_tr_b16 a[108:109], v17 offset:6272
    ds_read_b64_tr_b16 a[110:111], v17 offset:7040
    s_waitcnt lgkmcnt(0)
    s_waitcnt vmcnt(18)
    v_cmp_gt_u32 vcc, 1, v31
    s_cbranch_vccz L_z_16
    s_mov_b32 s14, 0
L_poll_17:
    buffer_load_dword v31, v5, s[76:79], 0 offen sc1
    s_add_u32 s14, s14, 1
    s_waitcnt vmcnt(0)
    v_cmp_gt_u32 vcc, 1, v31
    s_cbranch_vccz L_polled_18
    s_sleep 1
    s_cmp_lt_u32 s14, 0x40000
    s_cbranch_scc1 L_poll_17
L_polled_18:
L_z_16:
    buffer_load_dword v31, v18, s[80:83], 0 offen sc1
    s_add_u32 m0, s7, 6144
    s_nop 0
    buffer_load_dwordx4 v6, s[52:55], s88 offen offset:0 lds
    buffer_load_dwordx4 v7, s[52:55], s88 offen offset:1024 lds
    buffer_load_dwordx4 v8, s[52:55], s88 offen offset:2048 lds
    s_add_u32 m0, s7, 9216
    s_nop 0
    buffer_load_dwordx4 v9, s[52:55], s88 offen offset:0 lds
    buffer_load_dwordx4 v10, s[52:55], s88 offen offset:1024 lds
    buffer_load_dwordx4 v11, s[52:55], s88 offen offset:2048 lds
    s_waitcnt vmcnt(32)
    ds_read_b64_tr_b16 a[112:113], v16 offset:12288
    ds_read_b64_tr_b16 a[114:115], v16 offset:13056
    ds_read_b64_tr_b16 a[116:117], v17 offset:12288
    ds_read_b64_tr_b16 a[118:119], v17 offset:13056
    ds_read_b64_tr_b16 a[120:121], v16 offset:12352
    ds_read_b64_tr_b16 a[122:123], v16 offset:13120
    ds_read_b64_tr_b16 a[124:125], v17 offset:12352
    ds_read_b64_tr_b16 a[126:127], v17 offset:13120
    ds_read_b64_tr_b16 a[128:129], v16 offset:12416
    ds_read_b64_tr_b16 a[130:131], v16 offset:13184
    ds_read_b64_tr_b16 a[132:133], v17 offset:12416
    ds_read_b64_tr_b16 a[134:135], v17 offset:13184
    s_waitcnt lgkmcnt(0)
    s_waitcnt vmcnt(26)
    ds_read_b64_tr_b16 a[136:137], v16 offset:18432
    ds_read_b64_tr_b16 a[138:139], v16 offset:19200
    ds_read_b64_tr_b16 a[140:141], v17 offset:18432
    ds_read_b64_tr_b16 a[142:143], v17 offset:19200
    ds_read_b64_tr_b16 a[144:145], v16 offset:18496
    ds_read_b64_tr_b16 a[146:147], v16 offset:19264
    ds_read_b64_tr_b16 a[148:149], v17 offset:18496
    ds_read_b64_tr_b16 a[150:151], v17 offset:19264
    ds_read_b64_tr_b16 a[152:153], v16 offset:18560
    ds_read_b64_tr_b16 a[154:155], v16 offset:19328
    ds_read_b64_tr_b16 a[156:157], v17 offset:18560
    ds_read_b64_tr_b16 a[158:159], v17 offset:19328
    s_waitcnt lgkmcnt(0)
    s_waitcnt vmcnt(19)
    ds_read_b64_tr_b16 a[160:161], v16 offset:24576
    ds_read_b64_tr_b16 a[162:163], v16 offset:25344
    ds_read_b64_tr_b16 a[164:165], v17 offset:24576
    ds_read_b64_tr_b16 a[166:167], v17 offset:25344
    ds_read_b64_tr_b16 a[168:169], v16 offset:24640
    ds_read_b64_tr_b16 a[170:171], v16 offset:25408
    ds_read_b64_tr_b16 a[172:173], v17 offset:24640
    ds_read_b64_tr_b16 a[174:175], v17 offset:25408
    ds_read_b64_tr_b16 a[176:177], v16 offset:24704
    ds_read_b64_tr_b16 a[178:179], v16 offset:25472
    ds_read_b64_tr_b16 a[180:181], v17 offset:24704
    ds_read_b64_tr_b16 a[182:183], v17 offset:25472
    s_waitcnt lgkmcnt(0)
    s_waitcnt vmcnt(6)
    v_cmp_gt_u32 vcc, 32, v31
    s_cbranch_vccz L_fast_19
    s_mov_b32 s14, 0
L_poll_20:
    buffer_load_dword v31, v18, s[80:83], 0 offen sc1
    s_add_u32 s14, s14, 1
    s_waitcnt vmcnt(0)
    v_cmp_gt_u32 vcc, 32, v31
    s_cbranch_vccz L_polled_21
    s_sleep 1
    s_cmp_lt_u32 s14, 0x40000
    s_cbranch_scc1 L_poll_20
L_polled_21:
L_fast_19:
    buffer_load_dwordx4 v[32:35], v12, s[80:83], s92 offen offset:0 sc1
    buffer_load_dwordx4 v[36:39], v12, s[80:83], s92 offen offset:1024 sc1
    buffer_load_dwordx4 v[40:43], v12, s[80:83], s93 offen offset:0 sc1
    buffer_load_dwordx4 v[44:47], v12, s[80:83], s93 offen offset:1024 sc1
    buffer_load_dwordx4 v[48:51], v12, s[80:83], s94 offen offset:0 sc1
    buffer_load_dwordx4 v[52:55], v12, s[80:83], s94 offen offset:1024 sc1
    buffer_load_dwordx4 v[56:59], v12, s[80:83], s95 offen offset:0 sc1
    buffer_load_dwordx4 v[60:63], v12, s[80:83], s95 offen offset:1024 sc1
    buffer_load_dwordx4 v[64:67], v13, s[80:83], s92 offen offset:0 sc1
    buffer_load_dwordx4 v[68:71], v13, s[80:83], s92 offen offset:1024 sc1
    buffer_load_dwordx4 v[72:75], v13, s[80:83], s93 offen offset:0 sc1
    buffer_load_dwordx4 v[76:79], v13, s[80:83], s93 offen offset:1024 sc1
    buffer_load_dwordx4 v[80:83], v13, s[80:83], s94 offen offset:0 sc1
    buffer_load_dwordx4 v[84:87], v13, s[80:83], s94 offen offset:1024 sc1
    buffer_load_dwordx4 v[88:91], v13, s[80:83], s95 offen offset:0 sc1
    buffer_load_dwordx4 v[92:95], v13, s[80:83], s95 offen offset:1024 sc1
    s_waitcnt vmcnt(29)
    ds_read_b64_tr_b16 a[184:185], v16 offset:30720
    ds_read_b64_tr_b16 a[186:187], v16 offset:31488
    ds_read_b64_tr_b16 a[188:189], v17 offset:30720
    ds_read_b64_tr_b16 a[190:191], v17 offset:31488
    ds_read_b64_tr_b16 a[192:193], v16 offset:30784
    ds_read_b64_tr_b16 a[194:195], v16 offset:31552
    ds_read_b64_tr_b16 a[196:197], v17 offset:30784
    ds_read_b64_tr_b16 a[198:199], v17 offset:31552
    ds_read_b64_tr_b16 a[200:201], v16 offset:30848
    ds_read_b64_tr_b16 a[202:203], v16 offset:31616
    ds_read_b64_tr_b16 a[204:205], v17 offset:30848
    ds_read_b64_tr_b16 a[206:207], v17 offset:31616
    s_waitcnt lgkmcnt(0)
    s_waitcnt vmcnt(23)
    ds_read_b64_tr_b16 a[208:209], v16 offset:0
    ds_read_b64_tr_b16 a[210:211], v16 offset:768
    ds_read_b64_tr_b16 a[212:213], v17 offset:0
    ds_read_b64_tr_b16 a[214:215], v17 offset:768
    ds_read_b64_tr_b16 a[216:217], v16 offset:64
    ds_read_b64_tr_b16 a[218:219], v16 offset:832
    ds_read_b64_tr_b16 a[220:221], v17 offset:64
    ds_read_b64_tr_b16 a[222:223], v17 offset:832
    ds_read_b64_tr_b16 a[224:225], v16 offset:128
    ds_read_b64_tr_b16 a[226:227], v16 offset:896
    ds_read_b64_tr_b16 a[228:229], v17 offset:128
    ds_read_b64_tr_b16 a[230:231], v17 offset:896
    s_waitcnt lgkmcnt(0)
    s_waitcnt vmcnt(16)
    ds_read_b64_tr_b16 a[232:233], v16 offset:6144
    ds_read_b64_tr_b16 a[234:235], v16 offset:6912
    ds_read_b64_tr_b16 a[236:237], v17 offset:6144
    ds_read_b64_tr_b16 a[238:239], v17 offset:6912
    ds_read_b64_tr_b16 a[240:241], v16 offset:6208
    ds_read_b64_tr_b16 a[242:243], v16 offset:6976
    ds_read_b64_tr_b16 a[244:245], v17 offset:6208
    ds_read_b64_tr_b16 a[246:247], v17 offset:6976
    ds_read_b64_tr_b16 a[248:249], v16 offset:6272
    ds_read_b64_tr_b16 a[250:251], v16 offset:7040
    ds_read_b64_tr_b16 a[252:253], v17 offset:6272
    ds_read_b64_tr_b16 a[254:255], v17 offset:7040
    s_waitcnt lgkmcnt(0)
    s_waitcnt vmcnt(15)
    v_mfma_f32_16x16x32_bf16 v[160:163], a[64:67], v[32:35], 0
    buffer_load_dwordx4 v[96:99], v14, s[80:83], s92 offen offset:0 sc1
    s_waitcnt vmcnt(15)
    v_mfma_f32_16x16x32_bf16 v[160:163], a[88:91], v[36:39], v[160:163]
    s_waitcnt vmcnt(14)
    v_mfma_f32_16x16x32_bf16 v[160:163], a[112:115], v[40:43], v[160:163]
    s_waitcnt vmcnt(13)
    v_mfma_f32_16x16x32_bf16 v[160:163], a[136:139], v[44:47], v[160:163]
    s_waitcnt vmcnt(12)
    v_mfma_f32_16x16x32_bf16 v[160:163], a[160:163], v[48:51], v[160:163]
    s_waitcnt vmcnt(11)
    v_mfma_f32_16x16x32_bf16 v[160:163], a[184:187], v[52:55], v[160:163]
    buffer_load_dwordx4 v[100:103], v14, s[80:83], s92 offen offset:1024 sc1
    s_waitcnt vmcnt(11)
    v_mfma_f32_16x16x32_bf16 v[160:163], a[208:211], v[56:59], v[160:163]
    s_waitcnt vmcnt(10)
    v_mfma_f32_16x16x32_bf16 v[160:163], a[232:235], v[60:63], v[160:163]
    v_mfma_f32_16x16x32_bf16 v[164:167], a[68:71], v[32:35], 0
    v_mfma_f32_16x16x32_bf16 v[164:167], a[92:95], v[36:39], v[164:167]
    v_mfma_f32_16x16x32_bf16 v[164:167], a[116:119], v[40:43], v[164:167]
    v_mfma_f32_16x16x32_bf16 v[164:167], a[140:143], v[44:47], v[164:167]
    buffer_load_dwordx4 v[104:107], v14, s[80:83], s93 offen offset:0 sc1
    v_mfma_f32_16x16x32_bf16 v[164:167], a[164:167], v[48:51], v[164:167]
    v_mfma_f32_16x16x32_bf16 v[164:167], a[188:191], v[52:55], v[164:167]
    v_mfma_f32_16x16x32_bf16 v[164:167], a[212:215], v[56:59], v[164:167]
    v_mfma_f32_16x16x32_bf16 v[164:167], a[236:239], v[60:63], v[164:167]
    v_mfma_f32_16x16x32_bf16 v[168:171], a[72:75], v[32:35], 0
    v_mfma_f32_16x16x32_bf16 v[168:171], a[96:99], v[36:39], v[168:171]
    buffer_load_dwordx4 v[108:111], v14, s[80:83], s93 offen offset:1024 sc1
    v_mfma_f32_16x16x32_bf16 v[168:171], a[120:123], v[40:43], v[168:171]
    v_mfma_f32_16x16x32_bf16 v[168:171], a[144:147], v[44:47], v[168:171]
    v_mfma_f32_16x16x32_bf16 v[168:171], a[168:171], v[48:51], v[168:171]
    v_mfma_f32_16x16x32_bf16 v[168:171], a[192:195], v[52:55], v[168:171]
    v_mfma_f32_16x16x32_bf16 v[168:171], a[216:219], v[56:59], v[168:171]
    v_mfma_f32_16x16x32_bf16 v[168:171], a[240:243], v[60:63], v[168:171]
    v_mfma_f32_16x16x32_bf16 v[172:175], a[76:79], v[32:35], 0
    buffer_load_dwordx4 v[112:115], v14, s[80:83], s94 offen offset:0 sc1
    v_mfma_f32_16x16x32_bf16 v[172:175], a[100:103], v[36:39], v[172:175]
    v_mfma_f32_16x16x32_bf16 v[172:175], a[124:127], v[40:43], v[172:175]
    ds_write_b128 v26, v[160:163] offset:0
    v_mfma_f32_16x16x32_bf16 v[172:175], a[148:151], v[44:47], v[172:175]
    v_mfma_f32_16x16x32_bf16 v[172:175], a[172:175], v[48:51], v[172:175]
    v_mfma_f32_16x16x32_bf16 v[172:175], a[196:199], v[52:55], v[172:175]
    ds_write_b128 v26, v[164:167] offset:1024
    buffer_load_dwordx4 v[116:119], v14, s[80:83], s94 offen offset:1024 sc1
    v_mfma_f32_16x16x32_bf16 v[172:175], a[220:223], v[56:59], v[172:175]
    v_mfma_f32_16x16x32_bf16 v[172:175], a[244:247], v[60:63], v[172:175]
    v_mfma_f32_16x16x32_bf16 v[176:179], a[80:83], v[32:35], 0
    v_mfma_f32_16x16x32_bf16 v[176:179], a[104:107], v[36:39], v[176:179]
    ds_write_b128 v26, v[168:171] offset:2048
    v_mfma_f32_16x16x32_bf16 v[176:179], a[128:131], v[40:43], v[176:179]
    v_mfma_f32_16x16x32_bf16 v[176:179], a[152:155], v[44:47], v[176:179]
    buffer_load_dwordx4 v[120:123], v14, s[80:83], s95 offen offset:0 sc1
    v_mfma_f32_16x16x32_bf16 v[176:179], a[176:179], v[48:51], v[176:179]
    v_mfma_f32_16x16x32_bf16 v[176:179], a[200:203], v[52:55], v[176:179]
    v_mfma_f32_16x16x32_bf16 v[176:179], a[224:227], v[56:59], v[176:179]
    v_mfma_f32_16x16x32_bf16 v[176:179], a[248:251], v[60:63], v[176:179]
    v_mfma_f32_16x16x32_bf16 v[180:183], a[84:87], v[32:35], 0
    s_waitcnt lgkmcnt(0)
    s_barrier
    v_mfma_f32_16x16x32_bf16 v[180:183], a[108:111], v[36:39], v[180:183]
    ds_read_b128 v[184:187], v27 offset:0
    buffer_load_dwordx4 v[124:127], v14, s[80:83], s95 offen offset:1024 sc1
    v_mfma_f32_16x16x32_bf16 v[180:183], a[132:135], v[40:43], v[180:183]
    v_mfma_f32_16x16x32_bf16 v[180:183], a[156:159], v[44:47], v[180:183]
    ds_read_b128 v[188:191], v27 offset:1024
    v_mfma_f32_16x16x32_bf16 v[180:183], a[180:183], v[48:51], v[180:183]
    v_mfma_f32_16x16x32_bf16 v[180:183], a[204:207], v[52:55], v[180:183]
    ds_read_b128 v[192:195], v27 offset:2048
    v_mfma_f32_16x16x32_bf16 v[180:183], a[228:231], v[56:59], v[180:183]
    v_mfma_f32_16x16x32_bf16 v[180:183], a[252:255], v[60:63], v[180:183]
    s_waitcnt lgkmcnt(2)
    s_waitcnt vmcnt(15)
    v_mfma_f32_16x16x32_bf16 v[184:187], a[64:67], v[64:67], v[184:187]
    buffer_load_dwordx4 v[128:131], v15, s[80:83], s92 offen offset:0 sc1
    s_waitcnt vmcnt(15)
    v_mfma_f32_16x16x32_bf16 v[184:187], a[88:91], v[68:71], v[184:187]
    s_waitcnt vmcnt(14)
    v_mfma_f32_16x16x32_bf16 v[184:187], a[112:115], v[72:75], v[184:187]
    ds_write_b128 v26, v[172:175] offset:3072
    s_waitcnt vmcnt(13)
    v_mfma_f32_16x16x32_bf16 v[184:187], a[136:139], v[76:79], v[184:187]
    s_waitcnt vmcnt(12)
    v_mfma_f32_16x16x32_bf16 v[184:187], a[160:163], v[80:83], v[184:187]
    s_waitcnt vmcnt(11)
    v_mfma_f32_16x16x32_bf16 v[184:187], a[184:187], v[84:87], v[184:187]
    ds_write_b128 v26, v[176:179] offset:4096
    s_waitcnt vmcnt(10)
    v_mfma_f32_16x16x32_bf16 v[184:187], a[208:211], v[88:91], v[184:187]
    buffer_load_dwordx4 v[132:135], v15, s[80:83], s92 offen offset:1024 sc1
    s_waitcnt vmcnt(10)
    v_mfma_f32_16x16x32_bf16 v[184:187], a[232:235], v[92:95], v[184:187]
    s_waitcnt lgkmcnt(2)
    v_mfma_f32_16x16x32_bf16 v[188:191], a[68:71], v[64:67], v[188:191]
    v_mfma_f32_16x16x32_bf16 v[188:191], a[92:95], v[68:71], v[188:191]
    ds_write_b128 v26, v[180:183] offset:5120
    v_mfma_f32_16x16x32_bf16 v[188:191], a[116:119], v[72:75], v[188:191]
    v_mfma_f32_16x16x32_bf16 v[188:191], a[140:143], v[76:79], v[188:191]
    buffer_load_dwordx4 v[136:139], v15, s[80:83], s93 offen offset:0 sc1
    v_mfma_f32_16x16x32_bf16 v[188:191], a[164:167], v[80:83], v[188:191]
    v_mfma_f32_16x16x32_bf16 v[188:191], a[188:191], v[84:87], v[188:191]
    v_mfma_f32_16x16x32_bf16 v[188:191], a[212:215], v[88:91], v[188:191]
    v_mfma_f32_16x16x32_bf16 v[188:191], a[236:239], v[92:95], v[188:191]
    v_mfma_f32_16x16x32_bf16 v[192:195], a[72:75], v[64:67], v[192:195]
    s_waitcnt lgkmcnt(0)
    s_barrier
    v_mfma_f32_16x16x32_bf16 v[192:195], a[96:99], v[68:71], v[192:195]
    ds_read_b128 v[196:199], v27 offset:3072
    buffer_load_dwordx4 v[140:143], v15, s[80:83], s93 offen offset:1024 sc1
    v_mfma_f32_16x16x32_bf16 v[192:195], a[120:123], v[72:75], v[192:195]
    v_mfma_f32_16x16x32_bf16 v[192:195], a[144:147], v[76:79], v[192:195]
    ds_read_b128 v[200:203], v27 offset:4096
    v_mfma_f32_16x16x32_bf16 v[192:195], a[168:171], v[80:83], v[192:195]
    v_mfma_f32_16x16x32_bf16 v[192:195], a[192:195], v[84:87], v[192:195]
    ds_read_b128 v[204:207], v27 offset:5120
    v_mfma_f32_16x16x32_bf16 v[192:195], a[216:219], v[88:91], v[192:195]
    v_mfma_f32_16x16x32_bf16 v[192:195], a[240:243], v[92:95], v[192:195]
    s_waitcnt lgkmcnt(2)
    v_mfma_f32_16x16x32_bf16 v[196:199], a[76:79], v[64:67], v[196:199]
    buffer_load_dwordx4 v[144:147], v15, s[80:83], s94 offen offset:0 sc1
    v_mfma_f32_16x16x32_bf16 v[196:199], a[100:103], v[68:71], v[196:199]
    v_mfma_f32_16x16x32_bf16 v[196:199], a[124:127], v[72:75], v[196:199]
    ds_write_b128 v26, v[184:187] offset:0
    buffer_load_dwordx4 v[148:151], v15, s[80:83], s94 offen offset:1024 sc1
    v_mfma_f32_16x16x32_bf16 v[196:199], a[148:151], v[76:79], v[196:199]
    v_mfma_f32_16x16x32_bf16 v[196:199], a[172:175], v[80:83], v[196:199]
    buffer_load_dwordx4 v[152:155], v15, s[80:83], s95 offen offset:0 sc1
    v_mfma_f32_16x16x32_bf16 v[196:199], a[196:199], v[84:87], v[196:199]
    ds_write_b128 v26, v[188:191] offset:1024
    v_mfma_f32_16x16x32_bf16 v[196:199], a[220:223], v[88:91], v[196:199]
    buffer_load_dwordx4 v[156:159], v15, s[80:83], s95 offen offset:1024 sc1
    v_mfma_f32_16x16x32_bf16 v[196:199], a[244:247], v[92:95], v[196:199]
    s_waitcnt lgkmcnt(2)
    v_mfma_f32_16x16x32_bf16 v[200:203], a[80:83], v[64:67], v[200:203]
    v_mfma_f32_16x16x32_bf16 v[200:203], a[104:107], v[68:71], v[200:203]
    ds_write_b128 v26, v[192:195] offset:2048
    s_xor_b32 s92, s92, 262144
    v_mfma_f32_16x16x32_bf16 v[200:203], a[128:131], v[72:75], v[200:203]
    v_mfma_f32_16x16x32_bf16 v[200:203], a[152:155], v[76:79], v[200:203]
    s_xor_b32 s93, s93, 262144
    v_mfma_f32_16x16x32_bf16 v[200:203], a[176:179], v[80:83], v[200:203]
    v_mfma_f32_16x16x32_bf16 v[200:203], a[200:203], v[84:87], v[200:203]
    s_xor_b32 s94, s94, 262144
    v_mfma_f32_16x16x32_bf16 v[200:203], a[224:227], v[88:91], v[200:203]
    v_mfma_f32_16x16x32_bf16 v[200:203], a[248:251], v[92:95], v[200:203]
    v_mfma_f32_16x16x32_bf16 v[204:207], a[84:87], v[64:67], v[204:207]
    s_waitcnt lgkmcnt(0)
    s_barrier
    v_mfma_f32_16x16x32_bf16 v[204:207], a[108:111], v[68:71], v[204:207]
    ds_read_b128 v[160:163], v27 offset:0
    s_xor_b32 s95, s95, 262144
    v_mfma_f32_16x16x32_bf16 v[204:207], a[132:135], v[72:75], v[204:207]
    v_mov_b32 v5, 128
    v_mfma_f32_16x16x32_bf16 v[204:207], a[156:159], v[76:79], v[204:207]
    ds_read_b128 v[164:167], v27 offset:1024
    v_mfma_f32_16x16x32_bf16 v[204:207], a[180:183], v[80:83], v[204:207]
    buffer_load_dword v31, v5, s[76:79], 0 offen sc1
    v_mfma_f32_16x16x32_bf16 v[204:207], a[204:207], v[84:87], v[204:207]
    ds_read_b128 v[168:171], v27 offset:2048
    v_mfma_f32_16x16x32_bf16 v[204:207], a[228:231], v[88:91], v[204:207]
    v_mfma_f32_16x16x32_bf16 v[204:207], a[252:255], v[92:95], v[204:207]
    s_waitcnt lgkmcnt(2)
    s_waitcnt vmcnt(16)
    v_mfma_f32_16x16x32_bf16 v[160:163], a[64:67], v[96:99], v[160:163]
    buffer_load_dwordx4 v[32:35], v12, s[80:83], s92 offen offset:0 sc1
    s_waitcnt vmcnt(16)
    v_mfma_f32_16x16x32_bf16 v[160:163], a[88:91], v[100:103], v[160:163]
    s_waitcnt vmcnt(15)
    v_mfma_f32_16x16x32_bf16 v[160:163], a[112:115], v[104:107], v[160:163]
    ds_write_b128 v26, v[196:199] offset:3072
    s_waitcnt vmcnt(14)
    v_mfma_f32_16x16x32_bf16 v[160:163], a[136:139], v[108:111], v[160:163]
    s_waitcnt vmcnt(13)
    v_mfma_f32_16x16x32_bf16 v[160:163], a[160:163], v[112:115], v[160:163]
    s_waitcnt vmcnt(12)
    v_mfma_f32_16x16x32_bf16 v[160:163], a[184:187], v[116:119], v[160:163]
    ds_write_b128 v26, v[200:203] offset:4096
    s_waitcnt vmcnt(11)
    v_mfma_f32_16x16x32_bf16 v[160:163], a[208:211], v[120:123], v[160:163]
    buffer_load_dwordx4 v[36:39], v12, s[80:83], s92 offen offset:1024 sc1
    s_waitcnt vmcnt(11)
    v_mfma_f32_16x16x32_bf16 v[160:163], a[232:235], v[124:127], v[160:163]
    s_waitcnt lgkmcnt(2)
    v_mfma_f32_16x16x32_bf16 v[164:167], a[68:71], v[96:99], v[164:167]
    v_mfma_f32_16x16x32_bf16 v[164:167], a[92:95], v[100:103], v[164:167]
    ds_write_b128 v26, v[204:207] offset:5120
    v_mfma_f32_16x16x32_bf16 v[164:167], a[116:119], v[104:107], v[164:167]
    v_mfma_f32_16x16x32_bf16 v[164:167], a[140:143], v[108:111], v[164:167]
    buffer_load_dwordx4 v[40:43], v12, s[80:83], s93 offen offset:0 sc1
    v_mfma_f32_16x16x32_bf16 v[164:167], a[164:167], v[112:115], v[164:167]
    v_mfma_f32_16x16x32_bf16 v[164:167], a[188:191], v[116:119], v[164:167]
    v_mfma_f32_16x16x32_bf16 v[164:167], a[212:215], v[120:123], v[164:167]
    v_mfma_f32_16x16x32_bf16 v[164:167], a[236:239], v[124:127], v[164:167]
    v_mfma_f32_16x16x32_bf16 v[168:171], a[72:75], v[96:99], v[168:171]
    s_waitcnt lgkmcnt(0)
    s_barrier
    v_mfma_f32_16x16x32_bf16 v[168:171], a[96:99], v[100:103], v[168:171]
    ds_read_b128 v[172:175], v27 offset:3072
    buffer_load_dwordx4 v[44:47], v12, s[80:83], s93 offen offset:1024 sc1
    v_mfma_f32_16x16x32_bf16 v[168:171], a[120:123], v[104:107], v[168:171]
    v_mfma_f32_16x16x32_bf16 v[168:171], a[144:147], v[108:111], v[168:171]
    ds_read_b128 v[176:179], v27 offset:4096
    v_mfma_f32_16x16x32_bf16 v[168:171], a[168:171], v[112:115], v[168:171]
    v_mfma_f32_16x16x32_bf16 v[168:171], a[192:195], v[116:119], v[168:171]
    ds_read_b128 v[180:183], v27 offset:5120
    v_mfma_f32_16x16x32_bf16 v[168:171], a[216:219], v[120:123], v[168:171]
    v_mfma_f32_16x16x32_bf16 v[168:171], a[240:243], v[124:127], v[168:171]
    s_waitcnt lgkmcnt(2)
    v_mfma_f32_16x16x32_bf16 v[172:175], a[76:79], v[96:99], v[172:175]
    buffer_load_dwordx4 v[48:51], v12, s[80:83], s94 offen offset:0 sc1
    v_mfma_f32_16x16x32_bf16 v[172:175], a[100:103], v[100:103], v[172:175]
    v_mfma_f32_16x16x32_bf16 v[172:175], a[124:127], v[104:107], v[172:175]
    ds_write_b128 v26, v[160:163] offset:0
    v_mfma_f32_16x16x32_bf16 v[172:175], a[148:151], v[108:111], v[172:175]
    v_mfma_f32_16x16x32_bf16 v[172:175], a[172:175], v[112:115], v[172:175]
    v_mfma_f32_16x16x32_bf16 v[172:175], a[196:199], v[116:119], v[172:175]
    ds_write_b128 v26, v[164:167] offset:1024
    buffer_load_dwordx4 v[52:55], v12, s[80:83], s94 offen offset:1024 sc1
    v_mfma_f32_16x16x32_bf16 v[172:175], a[220:223], v[120:123], v[172:175]
    v_mfma_f32_16x16x32_bf16 v[172:175], a[244:247], v[124:127], v[172:175]
    s_waitcnt lgkmcnt(2)
    v_mfma_f32_16x16x32_bf16 v[176:179], a[80:83], v[96:99], v[176:179]
    v_mfma_f32_16x16x32_bf16 v[176:179], a[104:107], v[100:103], v[176:179]
    ds_write_b128 v26, v[168:171] offset:2048
    v_mfma_f32_16x16x32_bf16 v[176:179], a[128:131], v[104:107], v[176:179]
    v_mfma_f32_16x16x32_bf16 v[176:179], a[152:155], v[108:111], v[176:179]
    buffer_load_dwordx4 v[56:59], v12, s[80:83], s95 offen offset:0 sc1
    v_mfma_f32_16x16x32_bf16 v[176:179], a[176:179], v[112:115], v[176:179]
    v_mfma_f32_16x16x32_bf16 v[176:179], a[200:203], v[116:119], v[176:179]
    v_mfma_f32_16x16x32_bf16 v[176:179], a[224:227], v[120:123], v[176:179]
    v_mfma_f32_16x16x32_bf16 v[176:179], a[248:251], v[124:127], v[176:179]
    v_mfma_f32_16x16x32_bf16 v[180:183], a[84:87], v[96:99], v[180:183]
    s_waitcnt lgkmcnt(0)
    s_barrier
    v_mfma_f32_16x16x32_bf16 v[180:183], a[108:111], v[100:103], v[180:183]
    ds_read_b128 v[184:187], v27 offset:0
    buffer_load_dwordx4 v[60:63], v12, s[80:83], s95 offen offset:1024 sc1
    v_mfma_f32_16x16x32_bf16 v[180:183], a[132:135], v[104:107], v[180:183]
    v_mfma_f32_16x16x32_bf16 v[180:183], a[156:159], v[108:111], v[180:183]
    ds_read_b128 v[188:191], v27 offset:1024
    v_mfma_f32_16x16x32_bf16 v[180:183], a[180:183], v[112:115], v[180:183]
    v_mfma_f32_16x16x32_bf16 v[180:183], a[204:207], v[116:119], v[180:183]
    ds_read_b128 v[192:195], v27 offset:2048
    v_mfma_f32_16x16x32_bf16 v[180:183], a[228:231], v[120:123], v[180:183]
    v_mfma_f32_16x16x32_bf16 v[180:183], a[252:255], v[124:127], v[180:183]
    s_waitcnt lgkmcnt(2)
    s_waitcnt vmcnt(16)
    v_mfma_f32_16x16x32_bf16 v[184:187], a[64:67], v[128:131], v[184:187]
    buffer_load_dwordx4 v[64:67], v13, s[80:83], s92 offen offset:0 sc1
    s_waitcnt vmcnt(16)
    v_mfma_f32_16x16x32_bf16 v[184:187], a[88:91], v[132:135], v[184:187]
    buffer_load_dwordx4 v[68:71], v13, s[80:83], s92 offen offset:1024 sc1
    s_waitcnt vmcnt(16)
    v_mfma_f32_16x16x32_bf16 v[184:187], a[112:115], v[136:139], v[184:187]
    ds_write_b128 v26, v[172:175] offset:3072
    s_waitcnt vmcnt(15)
    v_mfma_f32_16x16x32_bf16 v[184:187], a[136:139], v[140:143], v[184:187]
    buffer_load_dwordx4 v[72:75], v13, s[80:83], s93 offen offset:0 sc1
    s_waitcnt vmcnt(15)
    v_mfma_f32_16x16x32_bf16 v[184:187], a[160:163], v[144:147], v[184:187]
    buffer_load_dwordx4 v[76:79], v13, s[80:83], s93 offen offset:1024 sc1
    s_waitcnt vmcnt(15)
    v_mfma_f32_16x16x32_bf16 v[184:187], a[184:187], v[148:151], v[184:187]
    ds_write_b128 v26, v[176:179] offset:4096
    s_waitcnt vmcnt(14)
    v_mfma_f32_16x16x32_bf16 v[184:187], a[208:211], v[152:155], v[184:187]
    v_lshlrev_b32 v160, 16, v208
    s_waitcnt vmcnt(13)
    v_mfma_f32_16x16x32_bf16 v[184:187], a[232:235], v[156:159], v[184:187]
    v_and_b32 v161, 0xffff0000, v208
    s_waitcnt lgkmcnt(2)
    v_mfma_f32_16x16x32_bf16 v[188:191], a[68:71], v[128:131], v[188:191]
    v_lshlrev_b32 v162, 16, v209
    v_mfma_f32_16x16x32_bf16 v[188:191], a[92:95], v[132:135], v[188:191]
    ds_write_b128 v26, v[180:183] offset:5120
    v_mfma_f32_16x16x32_bf16 v[188:191], a[116:119], v[136:139], v[188:191]
    v_and_b32 v163, 0xffff0000, v209
    v_mfma_f32_16x16x32_bf16 v[188:191], a[140:143], v[140:143], v[188:191]
    v_lshlrev_b32 v164, 16, v210
    v_mfma_f32_16x16x32_bf16 v[188:191], a[164:167], v[144:147], v[188:191]
    v_and_b32 v165, 0xffff0000, v210
    v_mfma_f32_16x16x32_bf16 v[188:191], a[188:191], v[148:151], v[188:191]
    v_mfma_f32_16x16x32_bf16 v[188:191], a[212:215], v[152:155], v[188:191]
    v_lshlrev_b32 v166, 16, v211
    v_mfma_f32_16x16x32_bf16 v[188:191], a[236:239], v[156:159], v[188:191]
    v_and_b32 v167, 0xffff0000, v211
    v_mfma_f32_16x16x32_bf16 v[192:195], a[72:75], v[128:131], v[192:195]
    s_waitcnt lgkmcnt(0)
    s_barrier
    v_mfma_f32_16x16x32_bf16 v[192:195], a[96:99], v[132:135], v[192:195]
    ds_read_b128 v[196:199], v27 offset:3072
    v_lshlrev_b32 v168, 16, v212
    v_mfma_f32_16x16x32_bf16 v[192:195], a[120:123], v[136:139], v[192:195]
    v_and_b32 v169, 0xffff0000, v212
    v_mfma_f32_16x16x32_bf16 v[192:195], a[144:147], v[140:143], v[192:195]
    ds_read_b128 v[200:203], v27 offset:4096
    v_mfma_f32_16x16x32_bf16 v[192:195], a[168:171], v[144:147], v[192:195]
    v_lshlrev_b32 v170, 16, v213
    v_mfma_f32_16x16x32_bf16 v[192:195], a[192:195], v[148:151], v[192:195]
    ds_read_b128 v[204:207], v27 offset:5120
    v_and_b32 v171, 0xffff0000, v213
    v_mfma_f32_16x16x32_bf16 v[192:195], a[216:219], v[152:155], v[192:195]
    v_mfma_f32_16x16x32_bf16 v[192:195], a[240:243], v[156:159], v[192:195]
    s_waitcnt lgkmcnt(2)
    v_mfma_f32_16x16x32_bf16 v[196:199], a[76:79], v[128:131], v[196:199]
    buffer_load_dwordx4 v[80:83], v13, s[80:83], s94 offen offset:0 sc1
    v_mfma_f32_16x16x32_bf16 v[196:199], a[100:103], v[132:135], v[196:199]
    buffer_load_dwordx4 v[84:87], v13, s[80:83], s94 offen offset:1024 sc1
    v_mfma_f32_16x16x32_bf16 v[196:199], a[124:127], v[136:139], v[196:199]
    buffer_load_dwordx4 v[88:91], v13, s[80:83], s95 offen offset:0 sc1
    v_mfma_f32_16x16x32_bf16 v[196:199], a[148:151], v[140:143], v[196:199]
    v_mfma_f32_16x16x32_bf16 v[196:199], a[172:175], v[144:147], v[196:199]
    buffer_load_dwordx4 v[92:95], v13, s[80:83], s95 offen offset:1024 sc1
    v_mfma_f32_16x16x32_bf16 v[196:199], a[196:199], v[148:151], v[196:199]
    v_lshlrev_b32 v172, 16, v214
    v_mfma_f32_16x16x32_bf16 v[196:199], a[220:223], v[152:155], v[196:199]
    v_mfma_f32_16x16x32_bf16 v[196:199], a[244:247], v[156:159], v[196:199]
    v_and_b32 v173, 0xffff0000, v214
    s_waitcnt lgkmcnt(0)
    v_mfma_f32_16x16x32_bf16 v[200:203], a[80:83], v[128:131], v[200:203]
    buffer_store_dwordx4 v[184:187], v20, s[80:83], 0 offen offset:0 sc1
    v_lshlrev_b32 v174, 16, v215
    v_mfma_f32_16x16x32_bf16 v[200:203], a[104:107], v[132:135], v[200:203]
    v_mfma_f32_16x16x32_bf16 v[200:203], a[128:131], v[136:139], v[200:203]
    v_and_b32 v175, 0xffff0000, v215
    v_mfma_f32_16x16x32_bf16 v[200:203], a[152:155], v[140:143], v[200:203]
    v_lshlrev_b32 v176, 16, v216
    v_mfma_f32_16x16x32_bf16 v[200:203], a[176:179], v[144:147], v[200:203]
    v_and_b32 v177, 0xffff0000, v216
    v_mfma_f32_16x16x32_bf16 v[200:203], a[200:203], v[148:151], v[200:203]
    buffer_store_dwordx4 v[188:191], v20, s[80:83], 0 offen offset:1024 sc1
    v_mfma_f32_16x16x32_bf16 v[200:203], a[224:227], v[152:155], v[200:203]
    v_lshlrev_b32 v178, 16, v217
    v_mfma_f32_16x16x32_bf16 v[200:203], a[248:251], v[156:159], v[200:203]
    v_and_b32 v179, 0xffff0000, v217
    v_mfma_f32_16x16x32_bf16 v[204:207], a[84:87], v[128:131], v[204:207]
    v_mfma_f32_16x16x32_bf16 v[204:207], a[108:111], v[132:135], v[204:207]
    v_lshlrev_b32 v180, 16, v218
    v_mfma_f32_16x16x32_bf16 v[204:207], a[132:135], v[136:139], v[204:207]
    buffer_store_dwordx4 v[192:195], v20, s[80:83], 0 offen offset:2048 sc1
    v_and_b32 v181, 0xffff0000, v218
    v_mfma_f32_16x16x32_bf16 v[204:207], a[156:159], v[140:143], v[204:207]
    v_mfma_f32_16x16x32_bf16 v[204:207], a[180:183], v[144:147], v[204:207]
    v_lshlrev_b32 v182, 16, v219
    v_mfma_f32_16x16x32_bf16 v[204:207], a[204:207], v[148:151], v[204:207]
    v_and_b32 v183, 0xffff0000, v219
    v_mfma_f32_16x16x32_bf16 v[204:207], a[228:231], v[152:155], v[204:207]
    v_mfma_f32_16x16x32_bf16 v[204:207], a[252:255], v[156:159], v[204:207]
    s_waitcnt vmcnt(18)
    v_mfma_f32_16x16x32_bf16 v[160:163], a[64:67], v[32:35], v[160:163]
    buffer_load_dwordx4 v[96:99], v14, s[80:83], s92 offen offset:0 sc1
    s_waitcnt vmcnt(18)
    v_mfma_f32_16x16x32_bf16 v[160:163], a[88:91], v[36:39], v[160:163]
    s_waitcnt vmcnt(17)
    v_mfma_f32_16x16x32_bf16 v[160:163], a[112:115], v[40:43], v[160:163]
    buffer_load_dwordx4 v[100:103], v14, s[80:83], s92 offen offset:1024 sc1
    s_waitcnt vmcnt(17)
    v_mfma_f32_16x16x32_bf16 v[160:163], a[136:139], v[44:47], v[160:163]
    s_waitcnt vmcnt(16)
    v_mfma_f32_16x16x32_bf16 v[160:163], a[160:163], v[48:51], v[160:163]
    buffer_load_dwordx4 v[104:107], v14, s[80:83], s93 offen offset:0 sc1
    s_waitcnt vmcnt(16)
    v_mfma_f32_16x16x32_bf16 v[160:163], a[184:187], v[52:55], v[160:163]
    s_waitcnt vmcnt(15)
    v_mfma_f32_16x16x32_bf16 v[160:163], a[208:211], v[56:59], v[160:163]
    buffer_load_dwordx4 v[108:111], v14, s[80:83], s93 offen offset:1024 sc1
    s_waitcnt vmcnt(15)
    v_mfma_f32_16x16x32_bf16 v[160:163], a[232:235], v[60:63], v[160:163]
    v_mfma_f32_16x16x32_bf16 v[164:167], a[68:71], v[32:35], v[164:167]
    buffer_store_dwordx4 v[196:199], v20, s[80:83], 0 offen offset:3072 sc1
    v_mfma_f32_16x16x32_bf16 v[164:167], a[92:95], v[36:39], v[164:167]
    s_add_u32 m0, s99, 0
    v_mfma_f32_16x16x32_bf16 v[164:167], a[116:119], v[40:43], v[164:167]
    v_mfma_f32_16x16x32_bf16 v[164:167], a[140:143], v[44:47], v[164:167]
    s_mov_b32 s101, 0
    v_mfma_f32_16x16x32_bf16 v[164:167], a[164:167], v[48:51], v[164:167]
    v_mfma_f32_16x16x32_bf16 v[164:167], a[188:191], v[52:55], v[164:167]
    buffer_store_dwordx4 v[200:203], v20, s[80:83], s84 offen offset:0 sc1
    buffer_load_dwordx4 v250, s[48:51], s101 offen offset:0 lds
    v_mfma_f32_16x16x32_bf16 v[164:167], a[212:215], v[56:59], v[164:167]
    v_mfma_f32_16x16x32_bf16 v[164:167], a[236:239], v[60:63], v[164:167]
    v_mfma_f32_16x16x32_bf16 v[168:171], a[72:75], v[32:35], v[168:171]
    buffer_load_dwordx4 v251, s[48:51], s101 offen offset:1024 lds
    v_mfma_f32_16x16x32_bf16 v[168:171], a[96:99], v[36:39], v[168:171]
    v_mfma_f32_16x16x32_bf16 v[168:171], a[120:123], v[40:43], v[168:171]
    buffer_store_dwordx4 v[204:207], v20, s[80:83], s84 offen offset:1024 sc1
    s_add_u32 m0, s99, 2048
    v_mfma_f32_16x16x32_bf16 v[168:171], a[144:147], v[44:47], v[168:171]
    v_mfma_f32_16x16x32_bf16 v[168:171], a[168:171], v[48:51], v[168:171]
    s_mov_b32 s101, 16384
    v_mfma_f32_16x16x32_bf16 v[168:171], a[192:195], v[52:55], v[168:171]
    v_mfma_f32_16x16x32_bf16 v[168:171], a[216:219], v[56:59], v[168:171]
    v_mfma_f32_16x16x32_bf16 v[168:171], a[240:243], v[60:63], v[168:171]
    v_mfma_f32_16x16x32_bf16 v[172:175], a[76:79], v[32:35], v[172:175]
    buffer_load_dwordx4 v[112:115], v14, s[80:83], s94 offen offset:0 sc1
    v_mfma_f32_16x16x32_bf16 v[172:175], a[100:103], v[36:39], v[172:175]
    v_mfma_f32_16x16x32_bf16 v[172:175], a[124:127], v[40:43], v[172:175]
    ds_write_b128 v26, v[160:163] offset:0
    buffer_load_dwordx4 v[116:119], v14, s[80:83], s94 offen offset:1024 sc1
    v_mfma_f32_16x16x32_bf16 v[172:175], a[148:151], v[44:47], v[172:175]
    v_mfma_f32_16x16x32_bf16 v[172:175], a[172:175], v[48:51], v[172:175]
    buffer_load_dwordx4 v[120:123], v14, s[80:83], s95 offen offset:0 sc1
    v_mfma_f32_16x16x32_bf16 v[172:175], a[196:199], v[52:55], v[172:175]
    ds_write_b128 v26, v[164:167] offset:1024
    v_mfma_f32_16x16x32_bf16 v[172:175], a[220:223], v[56:59], v[172:175]
    buffer_load_dwordx4 v[124:127], v14, s[80:83], s95 offen offset:1024 sc1
    v_mfma_f32_16x16x32_bf16 v[172:175], a[244:247], v[60:63], v[172:175]
    v_mfma_f32_16x16x32_bf16 v[176:179], a[80:83], v[32:35], v[176:179]
    v_mfma_f32_16x16x32_bf16 v[176:179], a[104:107], v[36:39], v[176:179]
    ds_write_b128 v26, v[168:171] offset:2048
    buffer_load_dwordx4 v250, s[48:51], s101 offen offset:0 lds
    v_mfma_f32_16x16x32_bf16 v[176:179], a[128:131], v[40:43], v[176:179]
    v_mfma_f32_16x16x32_bf16 v[176:179], a[152:155], v[44:47], v[176:179]
    buffer_load_dwordx4 v251, s[48:51], s101 offen offset:1024 lds
    v_mfma_f32_16x16x32_bf16 v[176:179], a[176:179], v[48:51], v[176:179]
    v_mfma_f32_16x16x32_bf16 v[176:179], a[200:203], v[52:55], v[176:179]
    s_add_u32 m0, s99, 4096
    v_mfma_f32_16x16x32_bf16 v[176:179], a[224:227], v[56:59], v[176:179]
    v_mfma_f32_16x16x32_bf16 v[176:179], a[248:251], v[60:63], v[176:179]
    v_mfma_f32_16x16x32_bf16 v[180:183], a[84:87], v[32:35], v[180:183]
    s_waitcnt lgkmcnt(0)
    s_barrier
    v_mfma_f32_16x16x32_bf16 v[180:183], a[108:111], v[36:39], v[180:183]
    ds_read_b128 v[184:187], v27 offset:0
    s_mov_b32 s101, 32768
    v_mfma_f32_16x16x32_bf16 v[180:183], a[132:135], v[40:43], v[180:183]
    buffer_load_dwordx4 v250, s[48:51], s101 offen offset:0 lds
    v_mfma_f32_16x16x32_bf16 v[180:183], a[156:159], v[44:47], v[180:183]
    ds_read_b128 v[188:191], v27 offset:1024
    v_mfma_f32_16x16x32_bf16 v[180:183], a[180:183], v[48:51], v[180:183]
    buffer_load_dwordx4 v251, s[48:51], s101 offen offset:1024 lds
    v_mfma_f32_16x16x32_bf16 v[180:183], a[204:207], v[52:55], v[180:183]
    ds_read_b128 v[192:195], v27 offset:2048
    v_mfma_f32_16x16x32_bf16 v[180:183], a[228:231], v[56:59], v[180:183]
    v_mfma_f32_16x16x32_bf16 v[180:183], a[252:255], v[60:63], v[180:183]
    s_waitcnt lgkmcnt(2)
    s_waitcnt vmcnt(27)
    v_mfma_f32_16x16x32_bf16 v[184:187], a[64:67], v[64:67], v[184:187]
    buffer_load_dwordx4 v[128:131], v15, s[80:83], s92 offen offset:0 sc1
    s_waitcnt vmcnt(27)
    v_mfma_f32_16x16x32_bf16 v[184:187], a[88:91], v[68:71], v[184:187]
    s_waitcnt vmcnt(26)
    v_mfma_f32_16x16x32_bf16 v[184:187], a[112:115], v[72:75], v[184:187]
    ds_write_b128 v26, v[172:175] offset:3072
    s_waitcnt vmcnt(25)
    v_mfma_f32_16x16x32_bf16 v[184:187], a[136:139], v[76:79], v[184:187]
    buffer_load_dwordx4 v[132:135], v15, s[80:83], s92 offen offset:1024 sc1
    s_waitcnt vmcnt(25)
    v_mfma_f32_16x16x32_bf16 v[184:187], a[160:163], v[80:83], v[184:187]
    buffer_load_dwordx4 v[136:139], v15, s[80:83], s93 offen offset:0 sc1
    s_waitcnt vmcnt(25)
    v_mfma_f32_16x16x32_bf16 v[184:187], a[184:187], v[84:87], v[184:187]
    ds_write_b128 v26, v[176:179] offset:4096
    s_waitcnt vmcnt(24)
    v_mfma_f32_16x16x32_bf16 v[184:187], a[208:211], v[88:91], v[184:187]
    buffer_load_dwordx4 v[140:143], v15, s[80:83], s93 offen offset:1024 sc1
    s_waitcnt vmcnt(24)
    v_mfma_f32_16x16x32_bf16 v[184:187], a[232:235], v[92:95], v[184:187]
    s_waitcnt lgkmcnt(2)
    v_mfma_f32_16x16x32_bf16 v[188:191], a[68:71], v[64:67], v[188:191]
    v_mfma_f32_16x16x32_bf16 v[188:191], a[92:95], v[68:71], v[188:191]
    ds_write_b128 v26, v[180:183] offset:5120
    s_add_u32 m0, s99, 6144
    v_mfma_f32_16x16x32_bf16 v[188:191], a[116:119], v[72:75], v[188:191]
    v_mfma_f32_16x16x32_bf16 v[188:191], a[140:143], v[76:79], v[188:191]
    s_mov_b32 s101, 49152
    v_mfma_f32_16x16x32_bf16 v[188:191], a[164:167], v[80:83], v[188:191]
    v_mfma_f32_16x16x32_bf16 v[188:191], a[188:191], v[84:87], v[188:191]
    buffer_load_dwordx4 v250, s[48:51], s101 offen offset:0 lds
    v_mfma_f32_16x16x32_bf16 v[188:191], a[212:215], v[88:91], v[188:191]
    v_mfma_f32_16x16x32_bf16 v[188:191], a[236:239], v[92:95], v[188:191]
    v_mfma_f32_16x16x32_bf16 v[192:195], a[72:75], v[64:67], v[192:195]
    s_waitcnt lgkmcnt(0)
    s_barrier
    v_mfma_f32_16x16x32_bf16 v[192:195], a[96:99], v[68:71], v[192:195]
    ds_read_b128 v[196:199], v27 offset:3072
    buffer_load_dwordx4 v251, s[48:51], s101 offen offset:1024 lds
    v_mfma_f32_16x16x32_bf16 v[192:195], a[120:123], v[72:75], v[192:195]
    s_add_u32 m0, s99, 8192
    v_mfma_f32_16x16x32_bf16 v[192:195], a[144:147], v[76:79], v[192:195]
    ds_read_b128 v[200:203], v27 offset:4096
    v_mfma_f32_16x16x32_bf16 v[192:195], a[168:171], v[80:83], v[192:195]
    s_mov_b32 s101, 65536
    v_mfma_f32_16x16x32_bf16 v[192:195], a[192:195], v[84:87], v[192:195]
    ds_read_b128 v[204:207], v27 offset:5120
    v_mfma_f32_16x16x32_bf16 v[192:195], a[216:219], v[88:91], v[192:195]
    v_mfma_f32_16x16x32_bf16 v[192:195], a[240:243], v[92:95], v[192:195]
    s_waitcnt lgkmcnt(2)
    v_mfma_f32_16x16x32_bf16 v[196:199], a[76:79], v[64:67], v[196:199]
    buffer_load_dwordx4 v[144:147], v15, s[80:83], s94 offen offset:0 sc1
    v_mfma_f32_16x16x32_bf16 v[196:199], a[100:103], v[68:71], v[196:199]
    v_mfma_f32_16x16x32_bf16 v[196:199], a[124:127], v[72:75], v[196:199]
    ds_write_b128 v26, v[184:187] offset:0
    buffer_load_dwordx4 v[148:151], v15, s[80:83], s94 offen offset:1024 sc1
    v_mfma_f32_16x16x32_bf16 v[196:199], a[148:151], v[76:79], v[196:199]
    v_mfma_f32_16x16x32_bf16 v[196:199], a[172:175], v[80:83], v[196:199]
    buffer_load_dwordx4 v[152:155], v15, s[80:83], s95 offen offset:0 sc1
    v_mfma_f32_16x16x32_bf16 v[196:199], a[196:199], v[84:87], v[196:199]
    ds_write_b128 v26, v[188:191] offset:1024
    v_mfma_f32_16x16x32_bf16 v[196:199], a[220:223], v[88:91], v[196:199]
    buffer_load_dwordx4 v[156:159], v15, s[80:83], s95 offen offset:1024 sc1
    v_mfma_f32_16x16x32_bf16 v[196:199], a[244:247], v[92:95], v[196:199]
    s_waitcnt lgkmcnt(2)
    v_mfma_f32_16x16x32_bf16 v[200:203], a[80:83], v[64:67], v[200:203]
    v_mfma_f32_16x16x32_bf16 v[200:203], a[104:107], v[68:71], v[200:203]
    ds_write_b128 v26, v[192:195] offset:2048
    buffer_load_dwordx4 v250, s[48:51], s101 offen offset:0 lds
    v_mfma_f32_16x16x32_bf16 v[200:203], a[128:131], v[72:75], v[200:203]
    v_mfma_f32_16x16x32_bf16 v[200:203], a[152:155], v[76:79], v[200:203]
    buffer_load_dwordx4 v251, s[48:51], s101 offen offset:1024 lds
    v_mfma_f32_16x16x32_bf16 v[200:203], a[176:179], v[80:83], v[200:203]
    v_mfma_f32_16x16x32_bf16 v[200:203], a[200:203], v[84:87], v[200:203]
    s_add_u32 m0, s99, 10240
    v_mfma_f32_16x16x32_bf16 v[200:203], a[224:227], v[88:91], v[200:203]
    v_mfma_f32_16x16x32_bf16 v[200:203], a[248:251], v[92:95], v[200:203]
    v_mfma_f32_16x16x32_bf16 v[204:207], a[84:87], v[64:67], v[204:207]
    s_waitcnt lgkmcnt(0)
    s_barrier
    v_mfma_f32_16x16x32_bf16 v[204:207], a[108:111], v[68:71], v[204:207]
    ds_read_b128 v[160:163], v27 offset:0
    s_mov_b32 s101, 81920
    v_mfma_f32_16x16x32_bf16 v[204:207], a[132:135], v[72:75], v[204:207]
    buffer_load_dwordx4 v250, s[48:51], s101 offen offset:0 lds
    v_mfma_f32_16x16x32_bf16 v[204:207], a[156:159], v[76:79], v[204:207]
    ds_read_b128 v[164:167], v27 offset:1024
    v_mfma_f32_16x16x32_bf16 v[204:207], a[180:183], v[80:83], v[204:207]
    buffer_load_dwordx4 v251, s[48:51], s101 offen offset:1024 lds
    v_mfma_f32_16x16x32_bf16 v[204:207], a[204:207], v[84:87], v[204:207]
    ds_read_b128 v[168:171], v27 offset:2048
    v_mfma_f32_16x16x32_bf16 v[204:207], a[228:231], v[88:91], v[204:207]
    v_mfma_f32_16x16x32_bf16 v[204:207], a[252:255], v[92:95], v[204:207]
    s_waitcnt lgkmcnt(2)
    s_waitcnt vmcnt(30)
    v_mfma_f32_16x16x32_bf16 v[160:163], a[64:67], v[96:99], v[160:163]
    s_waitcnt vmcnt(22)
    v_cmp_gt_u32 vcc, 1, v31
    s_cbranch_vccz L_z_22
    s_mov_b32 s14, 0
L_poll_23:
    buffer_load_dword v31, v5, s[76:79], 0 offen sc1
    s_add_u32 s14, s14, 1
    s_waitcnt vmcnt(0)
    v_cmp_gt_u32 vcc, 1, v31
    s_cbranch_vccz L_polled_24
    s_sleep 1
    s_cmp_lt_u32 s14, 0x40000
    s_cbranch_scc1 L_poll_23
L_polled_24:
L_z_22:
    s_waitcnt vmcnt(29)
    v_mfma_f32_16x16x32_bf16 v[160:163], a[88:91], v[100:103], v[160:163]
    s_waitcnt vmcnt(28)
    v_mfma_f32_16x16x32_bf16 v[160:163], a[112:115], v[104:107], v[160:163]
    ds_write_b128 v26, v[196:199] offset:3072
    s_waitcnt vmcnt(27)
    v_mfma_f32_16x16x32_bf16 v[160:163], a[136:139], v[108:111], v[160:163]
    buffer_store_dword v5, v21, s[80:83], 0 offen sc1
    s_waitcnt vmcnt(22)
    v_mfma_f32_16x16x32_bf16 v[160:163], a[160:163], v[112:115], v[160:163]
    s_waitcnt vmcnt(21)
    v_mfma_f32_16x16x32_bf16 v[160:163], a[184:187], v[116:119], v[160:163]
    ds_write_b128 v26, v[200:203] offset:4096
    s_waitcnt vmcnt(20)
    v_mfma_f32_16x16x32_bf16 v[160:163], a[208:211], v[120:123], v[160:163]
    s_add_u32 m0, s99, 12288
    s_waitcnt vmcnt(19)
    v_mfma_f32_16x16x32_bf16 v[160:163], a[232:235], v[124:127], v[160:163]
    s_waitcnt lgkmcnt(2)
    v_mfma_f32_16x16x32_bf16 v[164:167], a[68:71], v[96:99], v[164:167]
    s_mov_b32 s101, 98304
    v_mfma_f32_16x16x32_bf16 v[164:167], a[92:95], v[100:103], v[164:167]
    ds_write_b128 v26, v[204:207] offset:5120
    v_mfma_f32_16x16x32_bf16 v[164:167], a[116:119], v[104:107], v[164:167]
    v_mfma_f32_16x16x32_bf16 v[164:167], a[140:143], v[108:111], v[164:167]
    buffer_load_dwordx4 v250, s[48:51], s101 offen offset:0 lds
    v_mfma_f32_16x16x32_bf16 v[164:167], a[164:167], v[112:115], v[164:167]
    v_mfma_f32_16x16x32_bf16 v[164:167], a[188:191], v[116:119], v[164:167]
    v_mfma_f32_16x16x32_bf16 v[164:167], a[212:215], v[120:123], v[164:167]
    buffer_load_dwordx4 v251, s[48:51], s101 offen offset:1024 lds
    v_mfma_f32_16x16x32_bf16 v[164:167], a[236:239], v[124:127], v[164:167]
    v_mfma_f32_16x16x32_bf16 v[168:171], a[72:75], v[96:99], v[168:171]
    s_waitcnt lgkmcnt(0)
    s_barrier
    v_mfma_f32_16x16x32_bf16 v[168:171], a[96:99], v[100:103], v[168:171]
    ds_read_b128 v[172:175], v27 offset:3072
    s_add_u32 m0, s99, 14336
    v_mfma_f32_16x16x32_bf16 v[168:171], a[120:123], v[104:107], v[168:171]
    v_mfma_f32_16x16x32_bf16 v[168:171], a[144:147], v[108:111], v[168:171]
    ds_read_b128 v[176:179], v27 offset:4096
    v_mfma_f32_16x16x32_bf16 v[168:171], a[168:171], v[112:115], v[168:171]
    s_mov_b32 s101, 114688
    v_mfma_f32_16x16x32_bf16 v[168:171], a[192:195], v[116:119], v[168:171]
    ds_read_b128 v[180:183], v27 offset:5120
    v_mfma_f32_16x16x32_bf16 v[168:171], a[216:219], v[120:123], v[168:171]
    v_mfma_f32_16x16x32_bf16 v[168:171], a[240:243], v[124:127], v[168:171]
    s_waitcnt lgkmcnt(2)
    v_mfma_f32_16x16x32_bf16 v[172:175], a[76:79], v[96:99], v[172:175]
    buffer_load_dwordx4 v250, s[48:51], s101 offen offset:0 lds
    v_mfma_f32_16x16x32_bf16 v[172:175], a[100:103], v[100:103], v[172:175]
    v_mfma_f32_16x16x32_bf16 v[172:175], a[124:127], v[104:107], v[172:175]
    ds_write_b128 v26, v[160:163] offset:0
    v_mfma_f32_16x16x32_bf16 v[172:175], a[148:151], v[108:111], v[172:175]
    buffer_load_dwordx4 v251, s[48:51], s101 offen offset:1024 lds
    v_mfma_f32_16x16x32_bf16 v[172:175], a[172:175], v[112:115], v[172:175]
    v_mfma_f32_16x16x32_bf16 v[172:175], a[196:199], v[116:119], v[172:175]
    ds_write_b128 v26, v[164:167] offset:1024
    v_mfma_f32_16x16x32_bf16 v[172:175], a[220:223], v[120:123], v[172:175]
    v_mfma_f32_16x16x32_bf16 v[172:175], a[244:247], v[124:127], v[172:175]
    s_add_u32 m0, s100, 0
    s_waitcnt lgkmcnt(2)
    v_mfma_f32_16x16x32_bf16 v[176:179], a[80:83], v[96:99], v[176:179]
    v_mfma_f32_16x16x32_bf16 v[176:179], a[104:107], v[100:103], v[176:179]
    ds_write_b128 v26, v[168:171] offset:2048
    v_mfma_f32_16x16x32_bf16 v[176:179], a[128:131], v[104:107], v[176:179]
    v_mfma_f32_16x16x32_bf16 v[176:179], a[152:155], v[108:111], v[176:179]
    s_mov_b32 s101, 0
    v_mfma_f32_16x16x32_bf16 v[176:179], a[176:179], v[112:115], v[176:179]
    v_mfma_f32_16x16x32_bf16 v[176:179], a[200:203], v[116:119], v[176:179]
    v_mfma_f32_16x16x32_bf16 v[176:179], a[224:227], v[120:123], v[176:179]
    v_mfma_f32_16x16x32_bf16 v[176:179], a[248:251], v[124:127], v[176:179]
    buffer_load_dwordx4 v22, s[60:63], s101 offen offset:0 lds
    v_mfma_f32_16x16x32_bf16 v[180:183], a[84:87], v[96:99], v[180:183]
    s_waitcnt lgkmcnt(0)
    s_barrier
    v_mfma_f32_16x16x32_bf16 v[180:183], a[108:111], v[100:103], v[180:183]
    ds_read_b128 v[184:187], v27 offset:0
    v_mfma_f32_16x16x32_bf16 v[180:183], a[132:135], v[104:107], v[180:183]
    v_mfma_f32_16x16x32_bf16 v[180:183], a[156:159], v[108:111], v[180:183]
    ds_read_b128 v[188:191], v27 offset:1024
    buffer_load_dwordx4 v23, s[60:63], s101 offen offset:1024 lds
    v_mfma_f32_16x16x32_bf16 v[180:183], a[180:183], v[112:115], v[180:183]
    v_mfma_f32_16x16x32_bf16 v[180:183], a[204:207], v[116:119], v[180:183]
    ds_read_b128 v[192:195], v27 offset:2048
    v_mfma_f32_16x16x32_bf16 v[180:183], a[228:231], v[120:123], v[180:183]
    v_mfma_f32_16x16x32_bf16 v[180:183], a[252:255], v[124:127], v[180:183]
    s_waitcnt lgkmcnt(2)
    s_waitcnt vmcnt(20)
    v_mfma_f32_16x16x32_bf16 v[184:187], a[64:67], v[128:131], v[184:187]
    buffer_load_dword v31, v235, s[80:83], 0 offen sc1
    s_waitcnt vmcnt(20)
    v_mfma_f32_16x16x32_bf16 v[184:187], a[88:91], v[132:135], v[184:187]
    s_waitcnt vmcnt(19)
    v_mfma_f32_16x16x32_bf16 v[184:187], a[112:115], v[136:139], v[184:187]
    ds_write_b128 v26, v[172:175] offset:3072
    s_waitcnt vmcnt(18)
    v_mfma_f32_16x16x32_bf16 v[184:187], a[136:139], v[140:143], v[184:187]
    buffer_load_dwordx4 v24, s[60:63], s101 offen offset:2048 lds
    s_waitcnt vmcnt(16)
    v_mfma_f32_16x16x32_bf16 v[184:187], a[160:163], v[144:147], v[184:187]
    s_waitcnt vmcnt(15)
    v_mfma_f32_16x16x32_bf16 v[184:187], a[184:187], v[148:151], v[184:187]
    ds_write_b128 v26, v[176:179] offset:4096
    s_waitcnt vmcnt(14)
    v_mfma_f32_16x16x32_bf16 v[184:187], a[208:211], v[152:155], v[184:187]
    buffer_load_dwordx4 v25, s[60:63], s101 offen offset:3072 lds
    s_waitcnt vmcnt(14)
    v_mfma_f32_16x16x32_bf16 v[184:187], a[232:235], v[156:159], v[184:187]
    s_waitcnt lgkmcnt(2)
    v_mfma_f32_16x16x32_bf16 v[188:191], a[68:71], v[128:131], v[188:191]
    v_mfma_f32_16x16x32_bf16 v[188:191], a[92:95], v[132:135], v[188:191]
    ds_write_b128 v26, v[180:183] offset:5120
    s_add_u32 m0, s100, 4096
    v_mfma_f32_16x16x32_bf16 v[188:191], a[116:119], v[136:139], v[188:191]
    v_mfma_f32_16x16x32_bf16 v[188:191], a[140:143], v[140:143], v[188:191]
    v_mfma_f32_16x16x32_bf16 v[188:191], a[164:167], v[144:147], v[188:191]
    v_mfma_f32_16x16x32_bf16 v[188:191], a[188:191], v[148:151], v[188:191]
    s_mov_b32 s101, 131072
    v_mfma_f32_16x16x32_bf16 v[188:191], a[212:215], v[152:155], v[188:191]
    v_mfma_f32_16x16x32_bf16 v[188:191], a[236:239], v[156:159], v[188:191]
    v_mfma_f32_16x16x32_bf16 v[192:195], a[72:75], v[128:131], v[192:195]
    s_waitcnt lgkmcnt(0)
    s_barrier
    v_mfma_f32_16x16x32_bf16 v[192:195], a[96:99], v[132:135], v[192:195]
    ds_read_b128 v[196:199], v27 offset:3072
    buffer_load_dwordx4 v22, s[60:63], s101 offen offset:0 lds
    v_mfma_f32_16x16x32_bf16 v[192:195], a[120:123], v[136:139], v[192:195]
    v_mfma_f32_16x16x32_bf16 v[192:195], a[144:147], v[140:143], v[192:195]
    ds_read_b128 v[200:203], v27 offset:4096
    buffer_load_dwordx4 v23, s[60:63], s101 offen offset:1024 lds
    v_mfma_f32_16x16x32_bf16 v[192:195], a[168:171], v[144:147], v[192:195]
    v_mfma_f32_16x16x32_bf16 v[192:195], a[192:195], v[148:151], v[192:195]
    ds_read_b128 v[204:207], v27 offset:5120
    v_mfma_f32_16x16x32_bf16 v[192:195], a[216:219], v[152:155], v[192:195]
    v_mfma_f32_16x16x32_bf16 v[192:195], a[240:243], v[156:159], v[192:195]
    s_waitcnt lgkmcnt(2)
    v_mfma_f32_16x16x32_bf16 v[196:199], a[76:79], v[128:131], v[196:199]
    s_waitcnt vmcnt(4)
    v_cmp_gt_u32 vcc, 1, v31
    s_cbranch_vccz L_xf_25
    s_mov_b32 s14, 0
L_poll_26:
    buffer_load_dword v31, v235, s[80:83], 0 offen sc1
    s_add_u32 s14, s14, 1
    s_waitcnt vmcnt(0)
    v_cmp_gt_u32 vcc, 1, v31
    s_cbranch_vccz L_polled_27
    s_sleep 1
    s_cmp_lt_u32 s14, 0x40000
    s_cbranch_scc1 L_poll_26
L_polled_27:
L_xf_25:
    v_mfma_f32_16x16x32_bf16 v[196:199], a[100:103], v[132:135], v[196:199]
    buffer_load_dwordx4 v[160:163], v234, s[80:83], 0 offen offset:0 sc1
    v_mfma_f32_16x16x32_bf16 v[196:199], a[124:127], v[136:139], v[196:199]
    v_mfma_f32_16x16x32_bf16 v[196:199], a[148:151], v[140:143], v[196:199]
    buffer_load_dwordx4 v[164:167], v234, s[80:83], 0 offen offset:1024 sc1
    v_mfma_f32_16x16x32_bf16 v[196:199], a[172:175], v[144:147], v[196:199]
    v_mfma_f32_16x16x32_bf16 v[196:199], a[196:199], v[148:151], v[196:199]
    buffer_load_dwordx4 v[168:171], v234, s[80:83], 0 offen offset:2048 sc1
    v_mfma_f32_16x16x32_bf16 v[196:199], a[220:223], v[152:155], v[196:199]
    v_mfma_f32_16x16x32_bf16 v[196:199], a[244:247], v[156:159], v[196:199]
    buffer_load_dwordx4 v[172:175], v234, s[80:83], 0 offen offset:3072 sc1
    s_waitcnt lgkmcnt(0)
    v_mfma_f32_16x16x32_bf16 v[200:203], a[80:83], v[128:131], v[200:203]
    buffer_load_dwordx4 v[176:179], v234, s[80:83], s84 offen offset:0 sc1
    v_mfma_f32_16x16x32_bf16 v[200:203], a[104:107], v[132:135], v[200:203]
    v_mfma_f32_16x16x32_bf16 v[200:203], a[128:131], v[136:139], v[200:203]
    buffer_load_dwordx4 v[180:183], v234, s[80:83], s84 offen offset:1024 sc1
    v_mfma_f32_16x16x32_bf16 v[200:203], a[152:155], v[140:143], v[200:203]
    v_mfma_f32_16x16x32_bf16 v[200:203], a[176:179], v[144:147], v[200:203]
    buffer_load_dwordx4 v24, s[60:63], s101 offen offset:2048 lds
    v_mfma_f32_16x16x32_bf16 v[200:203], a[200:203], v[148:151], v[200:203]
    v_mfma_f32_16x16x32_bf16 v[200:203], a[224:227], v[152:155], v[200:203]
    buffer_load_dwordx4 v25, s[60:63], s101 offen offset:3072 lds
    v_mfma_f32_16x16x32_bf16 v[200:203], a[248:251], v[156:159], v[200:203]
    s_mov_b32 s92, 0xbdd2d3e8
    v_mfma_f32_16x16x32_bf16 v[204:207], a[84:87], v[128:131], v[204:207]
    v_mfma_f32_16x16x32_bf16 v[204:207], a[108:111], v[132:135], v[204:207]
    s_mov_b32 s93, 0xbdd2d3e8
    v_mfma_f32_16x16x32_bf16 v[204:207], a[132:135], v[136:139], v[204:207]
    v_mfma_f32_16x16x32_bf16 v[204:207], a[156:159], v[140:143], v[204:207]
    v_mov_b32 v20, 0xc0135761
    v_mfma_f32_16x16x32_bf16 v[204:207], a[180:183], v[144:147], v[204:207]
    v_mfma_f32_16x16x32_bf16 v[204:207], a[204:207], v[148:151], v[204:207]
    v_mov_b32 v21, 0xc0135761
    v_mfma_f32_16x16x32_bf16 v[204:207], a[228:231], v[152:155], v[204:207]
    v_mfma_f32_16x16x32_bf16 v[204:207], a[252:255], v[156:159], v[204:207]
    s_waitcnt vmcnt(6)
    v_pk_add_f32 v[32:33], v[184:185], v[160:161]
    v_pk_add_f32 v[34:35], v[186:187], v[162:163]
    v_pk_add_f32 v[36:37], v[188:189], v[164:165]
    v_pk_add_f32 v[38:39], v[190:191], v[166:167]
    v_pk_mul_f32 v[56:57], v[32:33], v[32:33]
    v_pk_mul_f32 v[58:59], v[34:35], v[34:35]
    v_pk_mul_f32 v[60:61], v[36:37], v[36:37]
    v_pk_mul_f32 v[62:63], v[38:39], v[38:39]
    v_pk_fma_f32 v[56:57], v[56:57], s[92:93], v[20:21]
    v_pk_fma_f32 v[58:59], v[58:59], s[92:93], v[20:21]
    v_pk_fma_f32 v[60:61], v[60:61], s[92:93], v[20:21]
    v_pk_fma_f32 v[62:63], v[62:63], s[92:93], v[20:21]
    v_pk_mul_f32 v[56:57], v[56:57], v[32:33]
    v_pk_mul_f32 v[58:59], v[58:59], v[34:35]
    v_pk_mul_f32 v[60:61], v[60:61], v[36:37]
    v_pk_mul_f32 v[62:63], v[62:63], v[38:39]
    v_exp_f32 v56, v56
    v_exp_f32 v57, v57
    v_exp_f32 v58, v58
    v_exp_f32 v59, v59
    v_exp_f32 v60, v60
    v_exp_f32 v61, v61
    v_exp_f32 v62, v62
    v_exp_f32 v63, v63
    v_add_f32 v56, 1.0, v56
    v_add_f32 v57, 1.0, v57
    v_add_f32 v58, 1.0, v58
    v_add_f32 v59, 1.0, v59
    v_add_f32 v60, 1.0, v60
    v_add_f32 v61, 1.0, v61
    v_add_f32 v62, 1.0, v62
    v_add_f32 v63, 1.0, v63
    v_rcp_f32 v56, v56
    v_rcp_f32 v57, v57
    v_rcp_f32 v58, v58
    v_rcp_f32 v59, v59
    v_rcp_f32 v60, v60
    v_rcp_f32 v61, v61
    v_rcp_f32 v62, v62
    v_rcp_f32 v63, v63
    v_pk_mul_f32 v[32:33], v[32:33], v[56:57]
    v_pk_mul_f32 v[34:35], v[34:35], v[58:59]
    v_pk_mul_f32 v[36:37], v[36:37], v[60:61]
    v_pk_mul_f32 v[38:39], v[38:39], v[62:63]
    v_cvt_pk_bf16_f32 v96, v32, v33
    v_cvt_pk_bf16_f32 v97, v34, v35
    v_cvt_pk_bf16_f32 v98, v36, v37
    v_cvt_pk_bf16_f32 v99, v38, v39
    buffer_store_dwordx4 v[96:99], v4, s[80:83], s15 offen offset:0 sc1
    s_waitcnt vmcnt(5)
    v_pk_add_f32 v[40:41], v[192:193], v[168:169]
    v_pk_add_f32 v[42:43], v[194:195], v[170:171]
    v_pk_add_f32 v[44:45], v[196:197], v[172:173]
    v_pk_add_f32 v[46:47], v[198:199], v[174:175]
    v_pk_mul_f32 v[64:65], v[40:41], v[40:41]
    v_pk_mul_f32 v[66:67], v[42:43], v[42:43]
    v_pk_mul_f32 v[68:69], v[44:45], v[44:45]
    v_pk_mul_f32 v[70:71], v[46:47], v[46:47]
    v_pk_fma_f32 v[64:65], v[64:65], s[92:93], v[20:21]
    v_pk_fma_f32 v[66:67], v[66:67], s[92:93], v[20:21]
    v_pk_fma_f32 v[68:69], v[68:69], s[92:93], v[20:21]
    v_pk_fma_f32 v[70:71], v[70:71], s[92:93], v[20:21]
    v_pk_mul_f32 v[64:65], v[64:65], v[40:41]
    v_pk_mul_f32 v[66:67], v[66:67], v[42:43]
    v_pk_mul_f32 v[68:69], v[68:69], v[44:45]
    v_pk_mul_f32 v[70:71], v[70:71], v[46:47]
    v_exp_f32 v64, v64
    v_exp_f32 v65, v65
    v_exp_f32 v66, v66
    v_exp_f32 v67, v67
    v_exp_f32 v68, v68
    v_exp_f32 v69, v69
    v_exp_f32 v70, v70
    v_exp_f32 v71, v71
    v_add_f32 v64, 1.0, v64
    v_add_f32 v65, 1.0, v65
    v_add_f32 v66, 1.0, v66
    v_add_f32 v67, 1.0, v67
    v_add_f32 v68, 1.0, v68
    v_add_f32 v69, 1.0, v69
    v_add_f32 v70, 1.0, v70
    v_add_f32 v71, 1.0, v71
    v_rcp_f32 v64, v64
    v_rcp_f32 v65, v65
    v_rcp_f32 v66, v66
    v_rcp_f32 v67, v67
    v_rcp_f32 v68, v68
    v_rcp_f32 v69, v69
    v_rcp_f32 v70, v70
    v_rcp_f32 v71, v71
    v_pk_mul_f32 v[40:41], v[40:41], v[64:65]
    v_pk_mul_f32 v[42:43], v[42:43], v[66:67]
    v_pk_mul_f32 v[44:45], v[44:45], v[68:69]
    v_pk_mul_f32 v[46:47], v[46:47], v[70:71]
    v_cvt_pk_bf16_f32 v100, v40, v41
    v_cvt_pk_bf16_f32 v101, v42, v43
    v_cvt_pk_bf16_f32 v102, v44, v45
    v_cvt_pk_bf16_f32 v103, v46, v47
    buffer_store_dwordx4 v[100:103], v19, s[80:83], s15 offen offset:1024 sc1
    s_waitcnt vmcnt(4)
    v_pk_add_f32 v[48:49], v[200:201], v[176:177]
    v_pk_add_f32 v[50:51], v[202:203], v[178:179]
    v_pk_add_f32 v[52:53], v[204:205], v[180:181]
    v_pk_add_f32 v[54:55], v[206:207], v[182:183]
    v_pk_mul_f32 v[72:73], v[48:49], v[48:49]
    v_pk_mul_f32 v[74:75], v[50:51], v[50:51]
    v_pk_mul_f32 v[76:77], v[52:53], v[52:53]
    v_pk_mul_f32 v[78:79], v[54:55], v[54:55]
    v_pk_fma_f32 v[72:73], v[72:73], s[92:93], v[20:21]
    v_pk_fma_f32 v[74:75], v[74:75], s[92:93], v[20:21]
    v_pk_fma_f32 v[76:77], v[76:77], s[92:93], v[20:21]
    v_pk_fma_f32 v[78:79], v[78:79], s[92:93], v[20:21]
    v_pk_mul_f32 v[72:73], v[72:73], v[48:49]
    v_pk_mul_f32 v[74:75], v[74:75], v[50:51]
    v_pk_mul_f32 v[76:77], v[76:77], v[52:53]
    v_pk_mul_f32 v[78:79], v[78:79], v[54:55]
    v_exp_f32 v72, v72
    v_exp_f32 v73, v73
    v_exp_f32 v74, v74
    v_exp_f32 v75, v75
    v_exp_f32 v76, v76
    v_exp_f32 v77, v77
    v_exp_f32 v78, v78
    v_exp_f32 v79, v79
    v_add_f32 v72, 1.0, v72
    v_add_f32 v73, 1.0, v73
    v_add_f32 v74, 1.0, v74
    v_add_f32 v75, 1.0, v75
    v_add_f32 v76, 1.0, v76
    v_add_f32 v77, 1.0, v77
    v_add_f32 v78, 1.0, v78
    v_add_f32 v79, 1.0, v79
    v_rcp_f32 v72, v72
    v_rcp_f32 v73, v73
    v_rcp_f32 v74, v74
    v_rcp_f32 v75, v75
    v_rcp_f32 v76, v76
    v_rcp_f32 v77, v77
    v_rcp_f32 v78, v78
    v_rcp_f32 v79, v79
    v_pk_mul_f32 v[48:49], v[48:49], v[72:73]
    v_pk_mul_f32 v[50:51], v[50:51], v[74:75]
    v_pk_mul_f32 v[52:53], v[52:53], v[76:77]
    v_pk_mul_f32 v[54:55], v[54:55], v[78:79]
    v_cvt_pk_bf16_f32 v104, v48, v49
    v_cvt_pk_bf16_f32 v105, v50, v51
    v_cvt_pk_bf16_f32 v106, v52, v53
    v_cvt_pk_bf16_f32 v107, v54, v55
    buffer_store_dwordx4 v[104:107], v19, s[80:83], s15 offen offset:2048 sc1
    buffer_load_dword v29, v240, s[80:83], 0 offen sc1
    s_add_u32 m0, s100, 8192
    s_mov_b32 s101, 262144
    buffer_load_dwordx4 v22, s[60:63], s101 offen offset:0 lds
    buffer_load_dwordx4 v23, s[60:63], s101 offen offset:1024 lds
    buffer_load_dwordx4 v24, s[60:63], s101 offen offset:2048 lds
    buffer_load_dwordx4 v25, s[60:63], s101 offen offset:3072 lds
    s_add_u32 m0, s100, 12288
    s_mov_b32 s101, 393216
    buffer_load_dwordx4 v22, s[60:63], s101 offen offset:0 lds
    buffer_load_dwordx4 v23, s[60:63], s101 offen offset:1024 lds
    buffer_load_dwordx4 v24, s[60:63], s101 offen offset:2048 lds
    buffer_load_dwordx4 v25, s[60:63], s101 offen offset:3072 lds
    s_lshl_b32 s12, s9, 11
    s_add_u32 s12, s12, 6979584
    s_waitcnt vmcnt(9)
    s_barrier
    s_cmp_lg_u32 s3, 0
    s_cbranch_scc1 L_arr_28
    v_lshlrev_b32 v30, 8, v1
    v_mov_b32 v31, 1
    s_mov_b64 exec, 255
    buffer_atomic_add v31, v30, s[80:83], s12 offen sc1
    s_mov_b64 exec, -1
L_arr_28:
    s_add_u32 m0, s100, 16384
    s_mov_b32 s101, 524288
    buffer_load_dwordx4 v22, s[60:63], s101 offen offset:0 lds
    buffer_load_dwordx4 v23, s[60:63], s101 offen offset:1024 lds
    buffer_load_dwordx4 v24, s[60:63], s101 offen offset:2048 lds
    buffer_load_dwordx4 v25, s[60:63], s101 offen offset:3072 lds
    s_add_u32 m0, s100, 20480
    s_mov_b32 s101, 655360
    buffer_load_dwordx4 v22, s[60:63], s101 offen offset:0 lds
    buffer_load_dwordx4 v23, s[60:63], s101 offen offset:1024 lds
    buffer_load_dwordx4 v24, s[60:63], s101 offen offset:2048 lds
    buffer_load_dwordx4 v25, s[60:63], s101 offen offset:3072 lds
    s_waitcnt vmcnt(16)
    s_branch L_p3
L_spare:
    s_mov_b32 s80, s38
    s_mov_b32 s81, s39
    s_mov_b32 s82, 12582912
    s_mov_b32 s83, 0x20000
    s_mov_b32 s76, s36
    s_mov_b32 s77, s37
    s_mov_b32 s78, 256
    s_mov_b32 s79, 0x20000
    s_mov_b32 s40, s16
    s_mov_b32 s41, s17
    s_mov_b32 s42, 2097152
    s_mov_b32 s43, 0x20000
    s_mov_b32 s44, s18
    s_mov_b32 s45, s19
    s_mov_b32 s46, 1572864
    s_mov_b32 s47, 0x20000
    s_and_b32 s12, s6, 15
    s_lshl_b32 s12, s12, 2
    s_add_u32 s12, s12, s3
    s_lshr_b32 s13, s12, 4
    s_lshl_b32 s13, s13, 17
    s_and_b32 s12, s12, 15
    s_lshl_b32 s12, s12, 12
    s_add_u32 s12, s12, s13
    s_lshl_b32 s13, s4, 19
    s_add_u32 s12, s12, s13
    s_xor_b32 s13, s5, 1
    s_lshl_b32 s13, s13, 16
    s_add_u32 s12, s12, s13
    v_lshlrev_b32 v117, 7, v1
    s_mov_b64 exec, 0xffffffff
    buffer_load_dword v157, v117, s[40:43], s12 offen
    s_mov_b64 exec, -1
    s_lshl_b32 s12, s6, 2
    s_add_u32 s12, s12, s3
    v_lshrrev_b32 v116, 3, v1
    v_mul_u32_u24 v116, 3072, v116
    v_bfe_u32 v117, v1, 2, 1
    v_lshl_add_u32 v116, v117, 10, v116
    v_and_b32 v117, 3, v1
    v_lshl_add_u32 v116, v117, 7, v116
    s_mul_i32 s13, s12, 12288
    s_lshl_b32 s14, s5, 9
    s_add_u32 s13, s13, s14
    s_mov_b64 exec, 0xffffffff
    buffer_load_dword v157, v116, s[44:47], s13 offen offset:1024
    s_mov_b64 exec, -1
    s_mov_b32 s48, s20
    s_mov_b32 s49, s21
    s_mov_b32 s50, 524288
    s_mov_b32 s51, 0x20000
    s_mov_b32 s60, s28
    s_mov_b32 s61, s29
    s_mov_b32 s62, 5636096
    s_mov_b32 s63, 0x20000
    s_mov_b32 s64, s30
    s_mov_b32 s65, s31
    s_mov_b32 s66, 4096
    s_mov_b32 s67, 0x20000
    s_mov_b32 s72, s34
    s_mov_b32 s73, s35
    s_mov_b32 s74, 2097152
    s_mov_b32 s75, 0x20000
    s_add_u32 s100, s7, 16384
    s_mov_b32 s99, s7
    v_lshrrev_b32 v30, 3, v1
    v_and_b32 v31, 7, v1
    v_and_b32 v22, 6, v30
    v_xor_b32 v31, v31, v22
    v_lshlrev_b32 v31, 4, v31
    v_lshl_add_u32 v22, v30, 12, v31
    v_lshl_add_u32 v250, v30, 10, v31
    s_lshl_b32 s13, s11, 7
    s_lshl_b32 s87, s3, 5
    s_add_u32 s87, s87, s13
    s_lshl_b32 s12, s3, 17
    s_add_u32 s12, s12, s13
    v_add_u32 v250, s12, v250
    s_mul_i32 s12, s3, 1441792
    s_lshl_b32 s13, s10, 7
    s_add_u32 s12, s12, s13
    v_add_u32 v22, s12, v22
    v_add_u32 v23, 31744, v22
    v_add_u32 v24, 63488, v22
    v_add_u32 v25, 95232, v22
    v_add_u32 v251, 7168, v250
    s_and_b32 s12, s10, 30
    s_add_u32 s12, s12, s5
    s_lshl_b32 s12, s12, 8
    s_add_u32 s12, s12, 6955008
    v_mov_b32 v240, s12
    s_lshl_b32 s12, s11, 3
    s_and_b32 s13, s2, 7
    s_add_u32 s12, s12, s13
    s_lshl_b32 s12, s12, 8
    s_add_u32 s12, s12, 6979584
    v_mov_b32 v241, s12
    v_lshrrev_b32 v228, 2, v2
    v_lshl_add_u32 v228, v3, 2, v228
    v_lshrrev_b32 v229, 1, v228
    v_and_b32 v229, 3, v229
    v_lshlrev_b32 v228, 7, v228
    v_lshl_add_u32 v228, v229, 5, v228
    v_and_b32 v229, 3, v2
    v_lshl_add_u32 v228, v229, 3, v228
    v_add_u32 v227, s99, v228
    v_add_u32 v228, s100, v228
    v_xor_b32 v229, 32, v228
    v_xor_b32 v230, 64, v228
    v_xor_b32 v231, 96, v228
    s_lshl_b32 s12, s10, 16
    s_lshl_b32 s13, s3, 12
    s_add_u32 s12, s12, s13
    s_add_u32 s12, s12, 4194304
    v_add_u32 v232, s12, v4
    v_add_u32 v233, 16384, v232
    s_mul_i32 s13, s11, 176128
    s_mul_i32 s12, s3, 11264
    s_add_u32 s13, s13, s12
    s_add_u32 s13, s13, 2359296
    s_add_u32 s12, s3, 1
    s_and_b32 s12, s12, 3
    s_lshl_b32 s14, s12, 5
    v_xor_b32 v224, s14, v227
    s_mul_i32 s14, s12, 40960
    s_add_u32 s14, s14, 24576
    v_add_u32 v245, s14, v4
    s_mul_i32 s12, s12, 44032
    s_add_u32 s12, s12, s13
    v_add_u32 v236, s12, v4
    s_add_u32 s12, s3, 2
    s_and_b32 s12, s12, 3
    s_lshl_b32 s14, s12, 5
    v_xor_b32 v225, s14, v227
    s_mul_i32 s14, s12, 40960
    s_add_u32 s14, s14, 20480
    v_add_u32 v246, s14, v4
    s_mul_i32 s12, s12, 44032
    s_add_u32 s12, s12, s13
    v_add_u32 v237, s12, v4
    s_add_u32 s12, s3, 3
    s_and_b32 s12, s12, 3
    s_lshl_b32 s14, s12, 5
    v_xor_b32 v226, s14, v227
    s_mul_i32 s14, s12, 40960
    s_add_u32 s14, s14, 16384
    v_add_u32 v247, s14, v4
    s_mul_i32 s12, s12, 44032
    s_add_u32 s12, s12, s13
    v_add_u32 v238, s12, v4
    s_add_u32 s12, s3, 4
    s_and_b32 s12, s12, 3
    s_lshl_b32 s14, s12, 5
    v_xor_b32 v227, s14, v227
    s_mul_i32 s14, s12, 40960
    v_add_u32 v244, s100, v4
    s_mul_i32 s12, s12, 44032
    s_add_u32 s12, s12, s13
    v_add_u32 v239, s12, v4
    s_mov_b32 s84, 4096
    s_mov_b32 s85, 8192
    s_mov_b32 s86, 10240
    s_mov_b32 s91, 32768
    s_cmp_eq_u32 s3, 3
    s_cselect_b32 s86, 0xc00000, s86
    s_lshl_b32 s12, s10, 6
    v_add_u32 v248, s12, v2
    v_lshlrev_b32 v242, 2, v248
    v_add_u32 v242, 6881280, v242
    v_lshlrev_b32 v243, 1, v248
    v_and_b32 v249, 1, v3
    v_lshl_add_u32 v248, v249, 4, v248
    v_lshlrev_b32 v248, 10, v248
    v_lshrrev_b32 v249, 1, v3
    v_lshl_add_u32 v248, v249, 4, v248
    v_add_u32 v249, 32768, v248
    buffer_load_ushort v252, v243, s[64:67], 0 offen offset:0
    buffer_load_ushort v253, v243, s[64:67], 0 offen offset:32
    buffer_load_ushort v254, v243, s[64:67], 0 offen offset:64
    buffer_load_ushort v255, v243, s[64:67], 0 offen offset:96
    v_lshlrev_b32 v30, 7, v1
    s_lshl_b32 s12, s9, 2
    s_add_u32 s12, s12, s3
    v_lshrrev_b32 v28, 3, v1
    v_mul_u32_u24 v28, 3072, v28
    v_and_b32 v29, 7, v1
    v_lshl_add_u32 v28, v29, 7, v28
    s_mul_i32 s13, s12, 49152
    buffer_load_dword v31, v28, s[44:47], s13 offen
    s_add_u32 s13, s13, 24576
    buffer_load_dword v31, v28, s[44:47], s13 offen
    s_lshl_b32 s12, s12, 14
    buffer_load_dword v31, v30, s[48:51], s12 offen
    s_add_u32 s12, s12, 8192
    buffer_load_dword v31, v30, s[48:51], s12 offen
    s_mul_i32 s12, s3, 1441792
    s_lshl_b32 s13, s9, 13
    s_add_u32 s12, s12, s13
    s_add_u32 s12, s12, 1114112
    s_mov_b32 s14, 0
L_spf_29:
    buffer_load_dword v31, v30, s[60:63], s12 offen
    s_add_u32 s12, s12, 65536
    s_add_u32 s14, s14, 1
    s_waitcnt vmcnt(2)
    s_cmp_lt_u32 s14, 5
    s_cbranch_scc1 L_spf_29
    s_waitcnt vmcnt(0)
    v_mov_b32 v5, 128
    s_mov_b32 s14, 0
L_poll_30:
    buffer_load_dword v31, v5, s[76:79], 0 offen sc1
    s_add_u32 s14, s14, 1
    s_waitcnt vmcnt(0)
    v_cmp_gt_u32 vcc, 1, v31
    s_cbranch_vccz L_polled_31
    s_sleep 1
    s_cmp_lt_u32 s14, 0x40000
    s_cbranch_scc1 L_poll_30
L_polled_31:
    v_mov_b32 v30, 6946816
    s_mov_b32 s14, 0
L_poll_32:
    buffer_load_dword v31, v30, s[80:83], 0 offen sc1
    s_add_u32 s14, s14, 1
    s_waitcnt vmcnt(0)
    v_cmp_gt_u32 vcc, 16, v31
    s_cbranch_vccz L_polled_33
    s_sleep 32
    s_cmp_lt_u32 s14, 0x40000
    s_cbranch_scc1 L_poll_32
L_polled_33:
    s_add_u32 m0, s99, 0
    s_mov_b32 s101, 0
    buffer_load_dwordx4 v250, s[48:51], s101 offen offset:0 lds
    buffer_load_dwordx4 v251, s[48:51], s101 offen offset:1024 lds
    s_add_u32 m0, s99, 2048
    s_mov_b32 s101, 16384
    buffer_load_dwordx4 v250, s[48:51], s101 offen offset:0 lds
    buffer_load_dwordx4 v251, s[48:51], s101 offen offset:1024 lds
    s_add_u32 m0, s99, 4096
    s_mov_b32 s101, 32768
    buffer_load_dwordx4 v250, s[48:51], s101 offen offset:0 lds
    buffer_load_dwordx4 v251, s[48:51], s101 offen offset:1024 lds
    s_add_u32 m0, s99, 6144
    s_mov_b32 s101, 49152
    buffer_load_dwordx4 v250, s[48:51], s101 offen offset:0 lds
    buffer_load_dwordx4 v251, s[48:51], s101 offen offset:1024 lds
    s_add_u32 m0, s99, 8192
    s_mov_b32 s101, 65536
    buffer_load_dwordx4 v250, s[48:51], s101 offen offset:0 lds
    buffer_load_dwordx4 v251, s[48:51], s101 offen offset:1024 lds
    s_add_u32 m0, s99, 10240
    s_mov_b32 s101, 81920
    buffer_load_dwordx4 v250, s[48:51], s101 offen offset:0 lds
    buffer_load_dwordx4 v251, s[48:51], s101 offen offset:1024 lds
    s_add_u32 m0, s99, 12288
    s_mov_b32 s101, 98304
    buffer_load_dwordx4 v250, s[48:51], s101 offen offset:0 lds
    buffer_load_dwordx4 v251, s[48:51], s101 offen offset:1024 lds
    s_add_u32 m0, s99, 14336
    s_mov_b32 s101, 114688
    buffer_load_dwordx4 v250, s[48:51], s101 offen offset:0 lds
    buffer_load_dwordx4 v251, s[48:51], s101 offen offset:1024 lds
    s_add_u32 m0, s100, 0
    s_mov_b32 s101, 0
    buffer_load_dwordx4 v22, s[60:63], s101 offen offset:0 lds
    buffer_load_dwordx4 v23, s[60:63], s101 offen offset:1024 lds
    buffer_load_dwordx4 v24, s[60:63], s101 offen offset:2048 lds
    buffer_load_dwordx4 v25, s[60:63], s101 offen offset:3072 lds
    s_add_u32 m0, s100, 4096
    s_mov_b32 s101, 131072
    buffer_load_dwordx4 v22, s[60:63], s101 offen offset:0 lds
    buffer_load_dwordx4 v23, s[60:63], s101 offen offset:1024 lds
    buffer_load_dwordx4 v24, s[60:63], s101 offen offset:2048 lds
    buffer_load_dwordx4 v25, s[60:63], s101 offen offset:3072 lds
    s_add_u32 m0, s100, 8192
    s_mov_b32 s101, 262144
    buffer_load_dwordx4 v22, s[60:63], s101 offen offset:0 lds
    buffer_load_dwordx4 v23, s[60:63], s101 offen offset:1024 lds
    buffer_load_dwordx4 v24, s[60:63], s101 offen offset:2048 lds
    buffer_load_dwordx4 v25, s[60:63], s101 offen offset:3072 lds
    s_add_u32 m0, s100, 12288
    s_mov_b32 s101, 393216
    buffer_load_dwordx4 v22, s[60:63], s101 offen offset:0 lds
    buffer_load_dwordx4 v23, s[60:63], s101 offen offset:1024 lds
    buffer_load_dwordx4 v24, s[60:63], s101 offen offset:2048 lds
    buffer_load_dwordx4 v25, s[60:63], s101 offen offset:3072 lds
    s_add_u32 m0, s100, 16384
    s_mov_b32 s101, 524288
    buffer_load_dwordx4 v22, s[60:63], s101 offen offset:0 lds
    buffer_load_dwordx4 v23, s[60:63], s101 offen offset:1024 lds
    buffer_load_dwordx4 v24, s[60:63], s101 offen offset:2048 lds
    buffer_load_dwordx4 v25, s[60:63], s101 offen offset:3072 lds
    s_add_u32 m0, s100, 20480
    s_mov_b32 s101, 655360
    buffer_load_dwordx4 v22, s[60:63], s101 offen offset:0 lds
    buffer_load_dwordx4 v23, s[60:63], s101 offen offset:1024 lds
    buffer_load_dwordx4 v24, s[60:63], s101 offen offset:2048 lds
    buffer_load_dwordx4 v25, s[60:63], s101 offen offset:3072 lds
    v_mov_b32 v29, 0
L_p3:
    s_waitcnt vmcnt(16)
    ds_read_b64_tr_b16 a[64:65], v224 offset:0
    ds_read_b64_tr_b16 a[66:67], v224 offset:2048
    ds_read_b64_tr_b16 a[68:69], v225 offset:0
    ds_read_b64_tr_b16 a[70:71], v225 offset:2048
    ds_read_b64_tr_b16 a[72:73], v226 offset:0
    ds_read_b64_tr_b16 a[74:75], v226 offset:2048
    ds_read_b64_tr_b16 a[76:77], v227 offset:0
    ds_read_b64_tr_b16 a[78:79], v227 offset:2048
    ds_read_b64_tr_b16 a[80:81], v224 offset:4096
    ds_read_b64_tr_b16 a[82:83], v224 offset:6144
    ds_read_b64_tr_b16 a[84:85], v225 offset:4096
    ds_read_b64_tr_b16 a[86:87], v225 offset:6144
    ds_read_b64_tr_b16 a[88:89], v226 offset:4096
    ds_read_b64_tr_b16 a[90:91], v226 offset:6144
    ds_read_b64_tr_b16 a[92:93], v227 offset:4096
    ds_read_b64_tr_b16 a[94:95], v227 offset:6144
    ds_read_b64_tr_b16 a[96:97], v224 offset:8192
    ds_read_b64_tr_b16 a[98:99], v224 offset:10240
    ds_read_b64_tr_b16 a[100:101], v225 offset:8192
    ds_read_b64_tr_b16 a[102:103], v225 offset:10240
    ds_read_b64_tr_b16 a[104:105], v226 offset:8192
    ds_read_b64_tr_b16 a[106:107], v226 offset:10240
    ds_read_b64_tr_b16 a[108:109], v227 offset:8192
    ds_read_b64_tr_b16 a[110:111], v227 offset:10240
    ds_read_b64_tr_b16 a[112:113], v224 offset:12288
    ds_read_b64_tr_b16 a[114:115], v224 offset:14336
    ds_read_b64_tr_b16 a[116:117], v225 offset:12288
    ds_read_b64_tr_b16 a[118:119], v225 offset:14336
    ds_read_b64_tr_b16 a[120:121], v226 offset:12288
    ds_read_b64_tr_b16 a[122:123], v226 offset:14336
    ds_read_b64_tr_b16 a[124:125], v227 offset:12288
    ds_read_b64_tr_b16 a[126:127], v227 offset:14336
    s_waitcnt vmcnt(20)
    ds_read_b64_tr_b16 a[0:1], v228 offset:0
    ds_read_b64_tr_b16 a[2:3], v228 offset:2048
    ds_read_b64_tr_b16 a[4:5], v229 offset:0
    ds_read_b64_tr_b16 a[6:7], v229 offset:2048
    ds_read_b64_tr_b16 a[8:9], v230 offset:0
    ds_read_b64_tr_b16 a[10:11], v230 offset:2048
    ds_read_b64_tr_b16 a[12:13], v231 offset:0
    ds_read_b64_tr_b16 a[14:15], v231 offset:2048
    s_waitcnt lgkmcnt(0)
    s_add_u32 m0, s100, 0
    s_mov_b32 s101, 786432
    buffer_load_dwordx4 v22, s[60:63], s101 offen offset:0 lds
    buffer_load_dwordx4 v23, s[60:63], s101 offen offset:1024 lds
    buffer_load_dwordx4 v24, s[60:63], s101 offen offset:2048 lds
    buffer_load_dwordx4 v25, s[60:63], s101 offen offset:3072 lds
    s_waitcnt vmcnt(20)
    ds_read_b64_tr_b16 a[16:17], v228 offset:4096
    ds_read_b64_tr_b16 a[18:19], v228 offset:6144
    ds_read_b64_tr_b16 a[20:21], v229 offset:4096
    ds_read_b64_tr_b16 a[22:23], v229 offset:6144
    ds_read_b64_tr_b16 a[24:25], v230 offset:4096
    ds_read_b64_tr_b16 a[26:27], v230 offset:6144
    ds_read_b64_tr_b16 a[28:29], v231 offset:4096
    ds_read_b64_tr_b16 a[30:31], v231 offset:6144
    s_waitcnt lgkmcnt(0)
    s_add_u32 m0, s100, 4096
    s_mov_b32 s101, 917504
    buffer_load_dwordx4 v22, s[60:63], s101 offen offset:0 lds
    buffer_load_dwordx4 v23, s[60:63], s101 offen offset:1024 lds
    buffer_load_dwordx4 v24, s[60:63], s101 offen offset:2048 lds
    buffer_load_dwordx4 v25, s[60:63], s101 offen offset:3072 lds
    s_waitcnt vmcnt(20)
    ds_read_b64_tr_b16 a[32:33], v228 offset:8192
    ds_read_b64_tr_b16 a[34:35], v228 offset:10240
    ds_read_b64_tr_b16 a[36:37], v229 offset:8192
    ds_read_b64_tr_b16 a[38:39], v229 offset:10240
    ds_read_b64_tr_b16 a[40:41], v230 offset:8192
    ds_read_b64_tr_b16 a[42:43], v230 offset:10240
    ds_read_b64_tr_b16 a[44:45], v231 offset:8192
    ds_read_b64_tr_b16 a[46:47], v231 offset:10240
    s_waitcnt lgkmcnt(0)
    s_add_u32 m0, s100, 8192
    s_mov_b32 s101, 1048576
    buffer_load_dwordx4 v22, s[60:63], s101 offen offset:0 lds
    buffer_load_dwordx4 v23, s[60:63], s101 offen offset:1024 lds
    buffer_load_dwordx4 v24, s[60:63], s101 offen offset:2048 lds
    buffer_load_dwordx4 v25, s[60:63], s101 offen offset:3072 lds
    s_waitcnt vmcnt(20)
    ds_read_b64_tr_b16 a[48:49], v228 offset:12288
    ds_read_b64_tr_b16 a[50:51], v228 offset:14336
    ds_read_b64_tr_b16 a[52:53], v229 offset:12288
    ds_read_b64_tr_b16 a[54:55], v229 offset:14336
    ds_read_b64_tr_b16 a[56:57], v230 offset:12288
    ds_read_b64_tr_b16 a[58:59], v230 offset:14336
    ds_read_b64_tr_b16 a[60:61], v231 offset:12288
    ds_read_b64_tr_b16 a[62:63], v231 offset:14336
    s_waitcnt lgkmcnt(0)
    s_add_u32 m0, s100, 12288
    s_mov_b32 s101, 1179648
    buffer_load_dwordx4 v22, s[60:63], s101 offen offset:0 lds
    buffer_load_dwordx4 v23, s[60:63], s101 offen offset:1024 lds
    buffer_load_dwordx4 v24, s[60:63], s101 offen offset:2048 lds
    buffer_load_dwordx4 v25, s[60:63], s101 offen offset:3072 lds
L_p3b:
    v_cmp_gt_u32 vcc, 8, v29
    s_cbranch_vccz L_of_34
    s_mov_b32 s14, 0
L_poll_35:
    buffer_load_dword v31, v240, s[80:83], 0 offen sc1
    s_add_u32 s14, s14, 1
    s_waitcnt vmcnt(0)
    v_cmp_gt_u32 vcc, 8, v31
    s_cbranch_vccz L_polled_36
    s_sleep 1
    s_cmp_lt_u32 s14, 0x40000
    s_cbranch_scc1 L_poll_35
L_polled_36:
L_of_34:
    buffer_load_dwordx4 a[128:131], v232, s[80:83], 0 offen offset:0 sc1
    buffer_load_dwordx4 a[132:135], v233, s[80:83], 0 offen offset:0 sc1
    buffer_load_dwordx4 a[136:139], v232, s[80:83], s91 offen offset:0 sc1
    buffer_load_dwordx4 a[140:143], v233, s[80:83], s91 offen offset:0 sc1
    buffer_load_dwordx4 a[144:147], v232, s[80:83], 0 offen offset:1024 sc1
    buffer_load_dwordx4 a[148:151], v233, s[80:83], 0 offen offset:1024 sc1
    buffer_load_dwordx4 a[152:155], v232, s[80:83], s91 offen offset:1024 sc1
    buffer_load_dwordx4 a[156:159], v233, s[80:83], s91 offen offset:1024 sc1
    buffer_load_dwordx4 a[160:163], v232, s[80:83], 0 offen offset:2048 sc1
    buffer_load_dwordx4 a[164:167], v233, s[80:83], 0 offen offset:2048 sc1
    buffer_load_dwordx4 a[168:171], v232, s[80:83], s91 offen offset:2048 sc1
    buffer_load_dwordx4 a[172:175], v233, s[80:83], s91 offen offset:2048 sc1
    s_waitcnt lgkmcnt(0)
    s_waitcnt vmcnt(11)
    v_mfma_f32_16x16x32_bf16 v[64:67], a[64:67], a[128:131], 0
    buffer_load_dwordx4 a[176:179], v232, s[80:83], 0 offen offset:3072 sc1
    v_mfma_f32_16x16x32_bf16 v[80:83], a[68:71], a[128:131], 0
    v_mfma_f32_16x16x32_bf16 v[96:99], a[72:75], a[128:131], 0
    buffer_load_dwordx4 a[180:183], v233, s[80:83], 0 offen offset:3072 sc1
    v_mfma_f32_16x16x32_bf16 v[112:115], a[76:79], a[128:131], 0
    s_waitcnt vmcnt(12)
    v_mfma_f32_16x16x32_bf16 v[68:71], a[64:67], a[132:135], 0
    v_mfma_f32_16x16x32_bf16 v[84:87], a[68:71], a[132:135], 0
    buffer_load_dwordx4 a[184:187], v232, s[80:83], s91 offen offset:3072 sc1
    v_mfma_f32_16x16x32_bf16 v[100:103], a[72:75], a[132:135], 0
    v_mfma_f32_16x16x32_bf16 v[116:119], a[76:79], a[132:135], 0
    s_waitcnt vmcnt(12)
    v_mfma_f32_16x16x32_bf16 v[72:75], a[64:67], a[136:139], 0
    buffer_load_dwordx4 a[188:191], v233, s[80:83], s91 offen offset:3072 sc1
    v_mfma_f32_16x16x32_bf16 v[88:91], a[68:71], a[136:139], 0
    v_mfma_f32_16x16x32_bf16 v[104:107], a[72:75], a[136:139], 0
    v_mfma_f32_16x16x32_bf16 v[120:123], a[76:79], a[136:139], 0
    buffer_load_dword v31, v241, s[80:83], 0 offen sc1
    s_waitcnt vmcnt(13)
    v_mfma_f32_16x16x32_bf16 v[76:79], a[64:67], a[140:143], 0
    v_mfma_f32_16x16x32_bf16 v[92:95], a[68:71], a[140:143], 0
    v_mfma_f32_16x16x32_bf16 v[108:111], a[72:75], a[140:143], 0
    v_mfma_f32_16x16x32_bf16 v[124:127], a[76:79], a[140:143], 0
    s_waitcnt vmcnt(12)
    v_mfma_f32_16x16x32_bf16 v[64:67], a[80:83], a[144:147], v[64:67]
    buffer_load_dword v32, v242, s[80:83], 0 offen offset:0 sc1
    v_mfma_f32_16x16x32_bf16 v[80:83], a[84:87], a[144:147], v[80:83]
    v_mfma_f32_16x16x32_bf16 v[96:99], a[88:91], a[144:147], v[96:99]
    v_mfma_f32_16x16x32_bf16 v[112:115], a[92:95], a[144:147], v[112:115]
    buffer_load_dword v34, v242, s[80:83], 0 offen offset:64 sc1
    s_waitcnt vmcnt(13)
    v_mfma_f32_16x16x32_bf16 v[68:71], a[80:83], a[148:151], v[68:71]
    v_mfma_f32_16x16x32_bf16 v[84:87], a[84:87], a[148:151], v[84:87]
    v_mfma_f32_16x16x32_bf16 v[100:103], a[88:91], a[148:151], v[100:103]
    v_mfma_f32_16x16x32_bf16 v[116:119], a[92:95], a[148:151], v[116:119]
    buffer_load_dword v36, v242, s[80:83], 0 offen offset:128 sc1
    s_waitcnt vmcnt(13)
    v_mfma_f32_16x16x32_bf16 v[72:75], a[80:83], a[152:155], v[72:75]
    v_mfma_f32_16x16x32_bf16 v[88:91], a[84:87], a[152:155], v[88:91]
    v_mfma_f32_16x16x32_bf16 v[104:107], a[88:91], a[152:155], v[104:107]
    buffer_load_dword v38, v242, s[80:83], 0 offen offset:192 sc1
    v_mfma_f32_16x16x32_bf16 v[120:123], a[92:95], a[152:155], v[120:123]
    s_waitcnt vmcnt(13)
    v_mfma_f32_16x16x32_bf16 v[76:79], a[80:83], a[156:159], v[76:79]
    v_mfma_f32_16x16x32_bf16 v[92:95], a[84:87], a[156:159], v[92:95]
    v_mfma_f32_16x16x32_bf16 v[108:111], a[88:91], a[156:159], v[108:111]
    v_mfma_f32_16x16x32_bf16 v[124:127], a[92:95], a[156:159], v[124:127]
    s_waitcnt vmcnt(12)
    v_mfma_f32_16x16x32_bf16 v[64:67], a[96:99], a[160:163], v[64:67]
    s_waitcnt vmcnt(4)
    v_mfma_f32_16x16x32_bf16 v[80:83], a[100:103], a[160:163], v[80:83]
    v_cmp_gt_u32 vcc, 15, v31
    v_mfma_f32_16x16x32_bf16 v[96:99], a[104:107], a[160:163], v[96:99]
    v_mfma_f32_16x16x32_bf16 v[112:115], a[108:111], a[160:163], v[112:115]
    s_nop 0
    s_waitcnt vmcnt(11)
    v_mfma_f32_16x16x32_bf16 v[68:71], a[96:99], a[164:167], v[68:71]
    v_mfma_f32_16x16x32_bf16 v[84:87], a[100:103], a[164:167], v[84:87]
    s_cmp_eq_u64 vcc, 0
    s_cselect_b32 s90, 0, 0xc00000
    v_mfma_f32_16x16x32_bf16 v[100:103], a[104:107], a[164:167], v[100:103]
    v_mfma_f32_16x16x32_bf16 v[116:119], a[108:111], a[164:167], v[116:119]
    buffer_load_dwordx4 a[192:195], v236, s[80:83], s90 offen offset:0 sc1
    s_waitcnt vmcnt(11)
    v_mfma_f32_16x16x32_bf16 v[72:75], a[96:99], a[168:171], v[72:75]
    buffer_load_dwordx4 a[196:199], v237, s[80:83], s90 offen offset:0 sc1
    v_mfma_f32_16x16x32_bf16 v[88:91], a[100:103], a[168:171], v[88:91]
    v_mfma_f32_16x16x32_bf16 v[104:107], a[104:107], a[168:171], v[104:107]
    buffer_load_dwordx4 a[200:203], v238, s[80:83], s90 offen offset:0 sc1
    v_mfma_f32_16x16x32_bf16 v[120:123], a[108:111], a[168:171], v[120:123]
    s_waitcnt vmcnt(12)
    v_mfma_f32_16x16x32_bf16 v[76:79], a[96:99], a[172:175], v[76:79]
    buffer_load_dwordx4 a[204:207], v239, s[80:83], s90 offen offset:0 sc1
    v_mfma_f32_16x16x32_bf16 v[92:95], a[100:103], a[172:175], v[92:95]
    v_mfma_f32_16x16x32_bf16 v[108:111], a[104:107], a[172:175], v[108:111]
    v_mfma_f32_16x16x32_bf16 v[124:127], a[108:111], a[172:175], v[124:127]
    s_waitcnt vmcnt(12)
    v_mfma_f32_16x16x32_bf16 v[64:67], a[112:115], a[176:179], v[64:67]
    buffer_load_dwordx4 a[208:211], v236, s[80:83], s90 offen offset:1024 sc1
    v_mfma_f32_16x16x32_bf16 v[80:83], a[116:119], a[176:179], v[80:83]
    v_mfma_f32_16x16x32_bf16 v[96:99], a[120:123], a[176:179], v[96:99]
    v_mfma_f32_16x16x32_bf16 v[112:115], a[124:127], a[176:179], v[112:115]
    buffer_load_dwordx4 a[212:215], v237, s[80:83], s90 offen offset:1024 sc1
    s_waitcnt vmcnt(13)
    v_mfma_f32_16x16x32_bf16 v[68:71], a[112:115], a[180:183], v[68:71]
    v_mfma_f32_16x16x32_bf16 v[84:87], a[116:119], a[180:183], v[84:87]
    v_mfma_f32_16x16x32_bf16 v[100:103], a[120:123], a[180:183], v[100:103]
    v_mfma_f32_16x16x32_bf16 v[116:119], a[124:127], a[180:183], v[116:119]
    buffer_load_dwordx4 a[216:219], v238, s[80:83], s90 offen offset:1024 sc1
    s_waitcnt vmcnt(13)
    v_mfma_f32_16x16x32_bf16 v[72:75], a[112:115], a[184:187], v[72:75]
    v_mfma_f32_16x16x32_bf16 v[88:91], a[116:119], a[184:187], v[88:91]
    v_mfma_f32_16x16x32_bf16 v[104:107], a[120:123], a[184:187], v[104:107]
    buffer_load_dwordx4 a[220:223], v239, s[80:83], s90 offen offset:1024 sc1
    v_mfma_f32_16x16x32_bf16 v[120:123], a[124:127], a[184:187], v[120:123]
    s_waitcnt vmcnt(13)
    v_mfma_f32_16x16x32_bf16 v[76:79], a[112:115], a[188:191], v[76:79]
    v_mfma_f32_16x16x32_bf16 v[92:95], a[116:119], a[188:191], v[92:95]
    v_mfma_f32_16x16x32_bf16 v[108:111], a[120:123], a[188:191], v[108:111]
    v_mfma_f32_16x16x32_bf16 v[124:127], a[124:127], a[188:191], v[124:127]
    s_waitcnt vmcnt(8)
    buffer_load_dwordx4 a[224:227], v236, s[80:83], s90 offen offset:2048 sc1
    v_sub_f32 v48, 1.0, v32
    v_sub_f32 v50, 1.0, v34
    v_sub_f32 v52, 1.0, v36
    v_sub_f32 v54, 1.0, v38
    v_max_f32 v48, 0xda24260, v48
    v_max_f32 v50, 0xda24260, v50
    v_max_f32 v52, 0xda24260, v52
    v_max_f32 v54, 0xda24260, v54
    v_rcp_f32 v56, v48
    v_rcp_f32 v57, v50
    v_rcp_f32 v58, v52
    v_rcp_f32 v59, v54
    v_lshlrev_b32 v40, 16, v252
    buffer_load_dwordx4 a[228:231], v237, s[80:83], s90 offen offset:2048 sc1
    v_lshlrev_b32 v42, 16, v253
    v_lshlrev_b32 v44, 16, v254
    v_lshlrev_b32 v46, 16, v255
    v_mul_f32 v32, v32, v56
    v_mul_f32 v34, v34, v57
    v_mul_f32 v36, v36, v58
    v_mul_f32 v38, v38, v59
    v_pk_mul_f32 v[64:65], v[64:65], v[32:33] op_sel_hi:[1,0]
    v_pk_mul_f32 v[66:67], v[66:67], v[32:33] op_sel_hi:[1,0]
    v_pk_mul_f32 v[68:69], v[68:69], v[34:35] op_sel_hi:[1,0]
    v_pk_mul_f32 v[70:71], v[70:71], v[34:35] op_sel_hi:[1,0]
    v_pk_mul_f32 v[72:73], v[72:73], v[36:37] op_sel_hi:[1,0]
    v_pk_mul_f32 v[74:75], v[74:75], v[36:37] op_sel_hi:[1,0]
    buffer_load_dwordx4 a[232:235], v238, s[80:83], s90 offen offset:2048 sc1
    v_pk_mul_f32 v[76:77], v[76:77], v[38:39] op_sel_hi:[1,0]
    v_pk_mul_f32 v[78:79], v[78:79], v[38:39] op_sel_hi:[1,0]
    v_pk_mul_f32 v[80:81], v[80:81], v[32:33] op_sel_hi:[1,0]
    v_pk_mul_f32 v[82:83], v[82:83], v[32:33] op_sel_hi:[1,0]
    v_pk_mul_f32 v[84:85], v[84:85], v[34:35] op_sel_hi:[1,0]
    v_pk_mul_f32 v[86:87], v[86:87], v[34:35] op_sel_hi:[1,0]
    v_pk_mul_f32 v[88:89], v[88:89], v[36:37] op_sel_hi:[1,0]
    v_pk_mul_f32 v[90:91], v[90:91], v[36:37] op_sel_hi:[1,0]
    v_pk_mul_f32 v[92:93], v[92:93], v[38:39] op_sel_hi:[1,0]
    v_pk_mul_f32 v[94:95], v[94:95], v[38:39] op_sel_hi:[1,0]
    v_pk_mul_f32 v[96:97], v[96:97], v[32:33] op_sel_hi:[1,0]
    v_pk_mul_f32 v[98:99], v[98:99], v[32:33] op_sel_hi:[1,0]
    v_pk_mul_f32 v[100:101], v[100:101], v[34:35] op_sel_hi:[1,0]
    buffer_load_dwordx4 a[236:239], v239, s[80:83], s90 offen offset:2048 sc1
    v_pk_mul_f32 v[102:103], v[102:103], v[34:35] op_sel_hi:[1,0]
    v_pk_mul_f32 v[104:105], v[104:105], v[36:37] op_sel_hi:[1,0]
    v_pk_mul_f32 v[106:107], v[106:107], v[36:37] op_sel_hi:[1,0]
    v_pk_mul_f32 v[108:109], v[108:109], v[38:39] op_sel_hi:[1,0]
    v_pk_mul_f32 v[110:111], v[110:111], v[38:39] op_sel_hi:[1,0]
    v_pk_fma_f32 v[112:113], v[112:113], v[32:33], v[40:41] op_sel_hi:[1,0,0]
    v_pk_fma_f32 v[114:115], v[114:115], v[32:33], v[40:41] op_sel_hi:[1,0,0]
    v_pk_fma_f32 v[116:117], v[116:117], v[34:35], v[42:43] op_sel_hi:[1,0,0]
    v_pk_fma_f32 v[118:119], v[118:119], v[34:35], v[42:43] op_sel_hi:[1,0,0]
    v_pk_fma_f32 v[120:121], v[120:121], v[36:37], v[44:45] op_sel_hi:[1,0,0]
    v_pk_fma_f32 v[122:123], v[122:123], v[36:37], v[44:45] op_sel_hi:[1,0,0]
    v_pk_fma_f32 v[124:125], v[124:125], v[38:39], v[46:47] op_sel_hi:[1,0,0]
    v_pk_fma_f32 v[126:127], v[126:127], v[38:39], v[46:47] op_sel_hi:[1,0,0]
    s_cmp_eq_u32 s90, 0
    s_cbranch_scc1 L_yj_37
    s_mov_b32 s14, 0
L_poll_38:
    buffer_load_dword v31, v241, s[80:83], 0 offen sc1
    s_add_u32 s14, s14, 1
    s_waitcnt vmcnt(0)
    v_cmp_gt_u32 vcc, 15, v31
    s_cbranch_vccz L_polled_39
    s_sleep 1
    s_cmp_lt_u32 s14, 0x40000
    s_cbranch_scc1 L_poll_38
L_polled_39:
    buffer_load_dwordx4 a[192:195], v236, s[80:83], 0 offen offset:0 sc1
    buffer_load_dwordx4 a[196:199], v237, s[80:83], 0 offen offset:0 sc1
    buffer_load_dwordx4 a[200:203], v238, s[80:83], 0 offen offset:0 sc1
    buffer_load_dwordx4 a[204:207], v239, s[80:83], 0 offen offset:0 sc1
    buffer_load_dwordx4 a[208:211], v236, s[80:83], 0 offen offset:1024 sc1
    buffer_load_dwordx4 a[212:215], v237, s[80:83], 0 offen offset:1024 sc1
    buffer_load_dwordx4 a[216:219], v238, s[80:83], 0 offen offset:1024 sc1
    buffer_load_dwordx4 a[220:223], v239, s[80:83], 0 offen offset:1024 sc1
    buffer_load_dwordx4 a[224:227], v236, s[80:83], 0 offen offset:2048 sc1
    buffer_load_dwordx4 a[228:231], v237, s[80:83], 0 offen offset:2048 sc1
    buffer_load_dwordx4 a[232:235], v238, s[80:83], 0 offen offset:2048 sc1
    buffer_load_dwordx4 a[236:239], v239, s[80:83], 0 offen offset:2048 sc1
L_yj_37:
    s_nop 1
    s_waitcnt vmcnt(11)
    v_mfma_f32_16x16x32_bf16 v[64:67], a[192:195], a[0:3], v[64:67]
    s_waitcnt vmcnt(33)
    v_mfma_f32_16x16x32_bf16 v[68:71], a[192:195], a[4:7], v[68:71]
    buffer_load_dwordx4 a[240:243], v236, s[80:83], 0 offen offset:3072 sc1
    v_mfma_f32_16x16x32_bf16 v[72:75], a[192:195], a[8:11], v[72:75]
    ds_read_b64_tr_b16 a[64:65], v228 offset:16384
    v_mfma_f32_16x16x32_bf16 v[76:79], a[192:195], a[12:15], v[76:79]
    ds_read_b64_tr_b16 a[66:67], v228 offset:18432
    s_waitcnt vmcnt(11)
    v_mfma_f32_16x16x32_bf16 v[80:83], a[196:199], a[0:3], v[80:83]
    buffer_load_dwordx4 a[244:247], v237, s[80:83], 0 offen offset:3072 sc1
    v_mfma_f32_16x16x32_bf16 v[84:87], a[196:199], a[4:7], v[84:87]
    ds_read_b64_tr_b16 a[68:69], v229 offset:16384
    v_mfma_f32_16x16x32_bf16 v[88:91], a[196:199], a[8:11], v[88:91]
    ds_read_b64_tr_b16 a[70:71], v229 offset:18432
    v_mfma_f32_16x16x32_bf16 v[92:95], a[196:199], a[12:15], v[92:95]
    buffer_load_dwordx4 a[248:251], v238, s[80:83], 0 offen offset:3072 sc1
    s_waitcnt vmcnt(12)
    v_mfma_f32_16x16x32_bf16 v[96:99], a[200:203], a[0:3], v[96:99]
    ds_read_b64_tr_b16 a[72:73], v230 offset:16384
    v_mfma_f32_16x16x32_bf16 v[100:103], a[200:203], a[4:7], v[100:103]
    ds_read_b64_tr_b16 a[74:75], v230 offset:18432
    v_mfma_f32_16x16x32_bf16 v[104:107], a[200:203], a[8:11], v[104:107]
    buffer_load_dwordx4 a[252:255], v239, s[80:83], 0 offen offset:3072 sc1
    v_mfma_f32_16x16x32_bf16 v[108:111], a[200:203], a[12:15], v[108:111]
    ds_read_b64_tr_b16 a[76:77], v231 offset:16384
    s_waitcnt vmcnt(12)
    v_mfma_f32_16x16x32_bf16 v[112:115], a[204:207], a[0:3], v[112:115]
    ds_read_b64_tr_b16 a[78:79], v231 offset:18432
    v_mfma_f32_16x16x32_bf16 v[116:119], a[204:207], a[4:7], v[116:119]
    v_mfma_f32_16x16x32_bf16 v[120:123], a[204:207], a[8:11], v[120:123]
    v_mfma_f32_16x16x32_bf16 v[124:127], a[204:207], a[12:15], v[124:127]
    s_waitcnt lgkmcnt(0)
    s_waitcnt vmcnt(11)
    v_mfma_f32_16x16x32_bf16 v[64:67], a[208:211], a[16:19], v[64:67]
    s_waitcnt vmcnt(37)
    buffer_load_dwordx4 a[128:131], v236, s[80:83], s84 offen offset:0 sc1
    v_mfma_f32_16x16x32_bf16 v[68:71], a[208:211], a[20:23], v[68:71]
    buffer_load_dwordx4 a[132:135], v237, s[80:83], s84 offen offset:0 sc1
    v_mfma_f32_16x16x32_bf16 v[72:75], a[208:211], a[24:27], v[72:75]
    ds_read_b64_tr_b16 a[80:81], v228 offset:20480
    buffer_load_dwordx4 a[136:139], v238, s[80:83], s84 offen offset:0 sc1
    v_mfma_f32_16x16x32_bf16 v[76:79], a[208:211], a[28:31], v[76:79]
    ds_read_b64_tr_b16 a[82:83], v228 offset:22528
    s_waitcnt vmcnt(13)
    v_mfma_f32_16x16x32_bf16 v[80:83], a[212:215], a[16:19], v[80:83]
    buffer_load_dwordx4 a[140:143], v239, s[80:83], s84 offen offset:0 sc1
    ds_read_b64_tr_b16 a[84:85], v229 offset:20480
    v_mfma_f32_16x16x32_bf16 v[84:87], a[212:215], a[20:23], v[84:87]
    s_add_u32 m0, s100, 16384
    v_mfma_f32_16x16x32_bf16 v[88:91], a[212:215], a[24:27], v[88:91]
    ds_read_b64_tr_b16 a[86:87], v229 offset:22528
    s_mov_b32 s101, 1310720
    v_mfma_f32_16x16x32_bf16 v[92:95], a[212:215], a[28:31], v[92:95]
    ds_read_b64_tr_b16 a[88:89], v230 offset:20480
    s_waitcnt vmcnt(13)
    v_mfma_f32_16x16x32_bf16 v[96:99], a[216:219], a[16:19], v[96:99]
    buffer_load_dwordx4 v22, s[60:63], s101 offen offset:0 lds
    ds_read_b64_tr_b16 a[90:91], v230 offset:22528
    v_mfma_f32_16x16x32_bf16 v[100:103], a[216:219], a[20:23], v[100:103]
    buffer_load_dwordx4 v23, s[60:63], s101 offen offset:1024 lds
    v_mfma_f32_16x16x32_bf16 v[104:107], a[216:219], a[24:27], v[104:107]
    ds_read_b64_tr_b16 a[92:93], v231 offset:20480
    buffer_load_dwordx4 v24, s[60:63], s101 offen offset:2048 lds
    v_mfma_f32_16x16x32_bf16 v[108:111], a[216:219], a[28:31], v[108:111]
    ds_read_b64_tr_b16 a[94:95], v231 offset:22528
    s_waitcnt vmcnt(15)
    v_mfma_f32_16x16x32_bf16 v[112:115], a[220:223], a[16:19], v[112:115]
    buffer_load_dwordx4 v25, s[60:63], s101 offen offset:3072 lds
    v_mfma_f32_16x16x32_bf16 v[116:119], a[220:223], a[20:23], v[116:119]
    v_mfma_f32_16x16x32_bf16 v[120:123], a[220:223], a[24:27], v[120:123]
    v_mfma_f32_16x16x32_bf16 v[124:127], a[220:223], a[28:31], v[124:127]
    s_waitcnt lgkmcnt(0)
    s_waitcnt vmcnt(15)
    v_mfma_f32_16x16x32_bf16 v[64:67], a[224:227], a[32:35], v[64:67]
    s_waitcnt vmcnt(45)
    v_mfma_f32_16x16x32_bf16 v[68:71], a[224:227], a[36:39], v[68:71]
    buffer_load_dwordx4 a[144:147], v236, s[80:83], s84 offen offset:1024 sc1
    v_mfma_f32_16x16x32_bf16 v[72:75], a[224:227], a[40:43], v[72:75]
    ds_read_b64_tr_b16 a[96:97], v228 offset:0
    v_mfma_f32_16x16x32_bf16 v[76:79], a[224:227], a[44:47], v[76:79]
    ds_read_b64_tr_b16 a[98:99], v228 offset:2048
    s_waitcnt vmcnt(15)
    v_mfma_f32_16x16x32_bf16 v[80:83], a[228:231], a[32:35], v[80:83]
    buffer_load_dwordx4 a[148:151], v237, s[80:83], s84 offen offset:1024 sc1
    v_mfma_f32_16x16x32_bf16 v[84:87], a[228:231], a[36:39], v[84:87]
    ds_read_b64_tr_b16 a[100:101], v229 offset:0
    v_mfma_f32_16x16x32_bf16 v[88:91], a[228:231], a[40:43], v[88:91]
    ds_read_b64_tr_b16 a[102:103], v229 offset:2048
    v_mfma_f32_16x16x32_bf16 v[92:95], a[228:231], a[44:47], v[92:95]
    buffer_load_dwordx4 a[152:155], v238, s[80:83], s84 offen offset:1024 sc1
    s_waitcnt vmcnt(16)
    v_mfma_f32_16x16x32_bf16 v[96:99], a[232:235], a[32:35], v[96:99]
    ds_read_b64_tr_b16 a[104:105], v230 offset:0
    v_mfma_f32_16x16x32_bf16 v[100:103], a[232:235], a[36:39], v[100:103]
    ds_read_b64_tr_b16 a[106:107], v230 offset:2048
    v_mfma_f32_16x16x32_bf16 v[104:107], a[232:235], a[40:43], v[104:107]
    buffer_load_dwordx4 a[156:159], v239, s[80:83], s84 offen offset:1024 sc1
    v_mfma_f32_16x16x32_bf16 v[108:111], a[232:235], a[44:47], v[108:111]
    ds_read_b64_tr_b16 a[108:109], v231 offset:0
    s_waitcnt vmcnt(16)
    v_mfma_f32_16x16x32_bf16 v[112:115], a[236:239], a[32:35], v[112:115]
    ds_read_b64_tr_b16 a[110:111], v231 offset:2048
    v_mfma_f32_16x16x32_bf16 v[116:119], a[236:239], a[36:39], v[116:119]
    v_mfma_f32_16x16x32_bf16 v[120:123], a[236:239], a[40:43], v[120:123]
    v_mfma_f32_16x16x32_bf16 v[124:127], a[236:239], a[44:47], v[124:127]
    s_waitcnt lgkmcnt(0)
    s_waitcnt vmcnt(15)
    v_mfma_f32_16x16x32_bf16 v[64:67], a[240:243], a[48:51], v[64:67]
    s_waitcnt vmcnt(49)
    v_mfma_f32_16x16x32_bf16 v[68:71], a[240:243], a[52:55], v[68:71]
    buffer_load_dwordx4 a[160:163], v236, s[80:83], s84 offen offset:2048 sc1
    v_mfma_f32_16x16x32_bf16 v[72:75], a[240:243], a[56:59], v[72:75]
    ds_read_b64_tr_b16 a[112:113], v228 offset:4096
    v_mfma_f32_16x16x32_bf16 v[76:79], a[240:243], a[60:63], v[76:79]
    ds_read_b64_tr_b16 a[114:115], v228 offset:6144
    s_waitcnt vmcnt(15)
    v_mfma_f32_16x16x32_bf16 v[80:83], a[244:247], a[48:51], v[80:83]
    buffer_load_dwordx4 a[164:167], v237, s[80:83], s84 offen offset:2048 sc1
    v_mfma_f32_16x16x32_bf16 v[84:87], a[244:247], a[52:55], v[84:87]
    ds_read_b64_tr_b16 a[116:117], v229 offset:4096
    v_mfma_f32_16x16x32_bf16 v[88:91], a[244:247], a[56:59], v[88:91]
    ds_read_b64_tr_b16 a[118:119], v229 offset:6144
    v_mfma_f32_16x16x32_bf16 v[92:95], a[244:247], a[60:63], v[92:95]
    buffer_load_dwordx4 a[168:171], v238, s[80:83], s84 offen offset:2048 sc1
    s_waitcnt vmcnt(16)
    v_mfma_f32_16x16x32_bf16 v[96:99], a[248:251], a[48:51], v[96:99]
    ds_read_b64_tr_b16 a[120:121], v230 offset:4096
    v_mfma_f32_16x16x32_bf16 v[100:103], a[248:251], a[52:55], v[100:103]
    ds_read_b64_tr_b16 a[122:123], v230 offset:6144
    v_mfma_f32_16x16x32_bf16 v[104:107], a[248:251], a[56:59], v[104:107]
    buffer_load_dwordx4 a[172:175], v239, s[80:83], s84 offen offset:2048 sc1
    v_mfma_f32_16x16x32_bf16 v[108:111], a[248:251], a[60:63], v[108:111]
    ds_read_b64_tr_b16 a[124:125], v231 offset:4096
    s_waitcnt vmcnt(16)
    v_mfma_f32_16x16x32_bf16 v[112:115], a[252:255], a[48:51], v[112:115]
    ds_read_b64_tr_b16 a[126:127], v231 offset:6144
    v_mfma_f32_16x16x32_bf16 v[116:119], a[252:255], a[52:55], v[116:119]
    v_mfma_f32_16x16x32_bf16 v[120:123], a[252:255], a[56:59], v[120:123]
    v_mfma_f32_16x16x32_bf16 v[124:127], a[252:255], a[60:63], v[124:127]
    s_waitcnt lgkmcnt(0)
    s_waitcnt vmcnt(15)
    v_mfma_f32_16x16x32_bf16 v[64:67], a[128:131], a[64:67], v[64:67]
    s_waitcnt vmcnt(53)
    v_mfma_f32_16x16x32_bf16 v[68:71], a[128:131], a[68:71], v[68:71]
    buffer_load_dwordx4 a[176:179], v236, s[80:83], s84 offen offset:3072 sc1
    v_mfma_f32_16x16x32_bf16 v[72:75], a[128:131], a[72:75], v[72:75]
    ds_read_b64_tr_b16 a[0:1], v228 offset:8192
    v_mfma_f32_16x16x32_bf16 v[76:79], a[128:131], a[76:79], v[76:79]
    ds_read_b64_tr_b16 a[2:3], v228 offset:10240
    s_waitcnt vmcnt(15)
    v_mfma_f32_16x16x32_bf16 v[80:83], a[132:135], a[64:67], v[80:83]
    buffer_load_dwordx4 a[192:195], v236, s[80:83], s85 offen offset:0 sc1
    v_mfma_f32_16x16x32_bf16 v[84:87], a[132:135], a[68:71], v[84:87]
    ds_read_b64_tr_b16 a[4:5], v229 offset:8192
    v_mfma_f32_16x16x32_bf16 v[88:91], a[132:135], a[72:75], v[88:91]
    ds_read_b64_tr_b16 a[6:7], v229 offset:10240
    v_mfma_f32_16x16x32_bf16 v[92:95], a[132:135], a[76:79], v[92:95]
    buffer_load_dwordx4 a[208:211], v236, s[80:83], s85 offen offset:1024 sc1
    s_waitcnt vmcnt(16)
    v_mfma_f32_16x16x32_bf16 v[96:99], a[136:139], a[64:67], v[96:99]
    ds_read_b64_tr_b16 a[8:9], v230 offset:8192
    v_mfma_f32_16x16x32_bf16 v[100:103], a[136:139], a[68:71], v[100:103]
    ds_read_b64_tr_b16 a[10:11], v230 offset:10240
    v_mfma_f32_16x16x32_bf16 v[104:107], a[136:139], a[72:75], v[104:107]
    buffer_load_dwordx4 a[224:227], v236, s[80:83], s86 offen offset:0 sc1
    v_mfma_f32_16x16x32_bf16 v[108:111], a[136:139], a[76:79], v[108:111]
    ds_read_b64_tr_b16 a[12:13], v231 offset:8192
    s_waitcnt vmcnt(16)
    v_mfma_f32_16x16x32_bf16 v[112:115], a[140:143], a[64:67], v[112:115]
    ds_read_b64_tr_b16 a[14:15], v231 offset:10240
    v_mfma_f32_16x16x32_bf16 v[116:119], a[140:143], a[68:71], v[116:119]
    v_mfma_f32_16x16x32_bf16 v[120:123], a[140:143], a[72:75], v[120:123]
    v_mfma_f32_16x16x32_bf16 v[124:127], a[140:143], a[76:79], v[124:127]
    s_waitcnt lgkmcnt(0)
    s_waitcnt vmcnt(11)
    v_mfma_f32_16x16x32_bf16 v[64:67], a[144:147], a[80:83], v[64:67]
    s_waitcnt vmcnt(57)
    v_mfma_f32_16x16x32_bf16 v[68:71], a[144:147], a[84:87], v[68:71]
    buffer_load_dwordx4 a[180:183], v237, s[80:83], s84 offen offset:3072 sc1
    v_mfma_f32_16x16x32_bf16 v[72:75], a[144:147], a[88:91], v[72:75]
    ds_read_b64_tr_b16 a[16:17], v228 offset:12288
    v_mfma_f32_16x16x32_bf16 v[76:79], a[144:147], a[92:95], v[76:79]
    ds_read_b64_tr_b16 a[18:19], v228 offset:14336
    s_waitcnt vmcnt(11)
    v_mfma_f32_16x16x32_bf16 v[80:83], a[148:151], a[80:83], v[80:83]
    buffer_load_dwordx4 a[196:199], v237, s[80:83], s85 offen offset:0 sc1
    v_mfma_f32_16x16x32_bf16 v[84:87], a[148:151], a[84:87], v[84:87]
    ds_read_b64_tr_b16 a[20:21], v229 offset:12288
    v_mfma_f32_16x16x32_bf16 v[88:91], a[148:151], a[88:91], v[88:91]
    ds_read_b64_tr_b16 a[22:23], v229 offset:14336
    v_mfma_f32_16x16x32_bf16 v[92:95], a[148:151], a[92:95], v[92:95]
    buffer_load_dwordx4 a[212:215], v237, s[80:83], s85 offen offset:1024 sc1
    s_waitcnt vmcnt(12)
    v_mfma_f32_16x16x32_bf16 v[96:99], a[152:155], a[80:83], v[96:99]
    ds_read_b64_tr_b16 a[24:25], v230 offset:12288
    v_mfma_f32_16x16x32_bf16 v[100:103], a[152:155], a[84:87], v[100:103]
    ds_read_b64_tr_b16 a[26:27], v230 offset:14336
    v_mfma_f32_16x16x32_bf16 v[104:107], a[152:155], a[88:91], v[104:107]
    buffer_load_dwordx4 a[228:231], v237, s[80:83], s86 offen offset:0 sc1
    v_mfma_f32_16x16x32_bf16 v[108:111], a[152:155], a[92:95], v[108:111]
    ds_read_b64_tr_b16 a[28:29], v231 offset:12288
    s_waitcnt vmcnt(12)
    v_mfma_f32_16x16x32_bf16 v[112:115], a[156:159], a[80:83], v[112:115]
    ds_read_b64_tr_b16 a[30:31], v231 offset:14336
    v_mfma_f32_16x16x32_bf16 v[116:119], a[156:159], a[84:87], v[116:119]
    v_mfma_f32_16x16x32_bf16 v[120:123], a[156:159], a[88:91], v[120:123]
    v_mfma_f32_16x16x32_bf16 v[124:127], a[156:159], a[92:95], v[124:127]
    s_waitcnt lgkmcnt(0)
    s_waitcnt vmcnt(11)
    v_mfma_f32_16x16x32_bf16 v[64:67], a[160:163], a[96:99], v[64:67]
    s_waitcnt vmcnt(16)
    v_mfma_f32_16x16x32_bf16 v[68:71], a[160:163], a[100:103], v[68:71]
    buffer_load_dwordx4 a[184:187], v238, s[80:83], s84 offen offset:3072 sc1
    v_mfma_f32_16x16x32_bf16 v[72:75], a[160:163], a[104:107], v[72:75]
    ds_read_b64_tr_b16 a[32:33], v228 offset:16384
    v_mfma_f32_16x16x32_bf16 v[76:79], a[160:163], a[108:111], v[76:79]
    ds_read_b64_tr_b16 a[34:35], v228 offset:18432
    s_waitcnt vmcnt(11)
    v_mfma_f32_16x16x32_bf16 v[80:83], a[164:167], a[96:99], v[80:83]
    buffer_load_dwordx4 a[200:203], v238, s[80:83], s85 offen offset:0 sc1
    v_mfma_f32_16x16x32_bf16 v[84:87], a[164:167], a[100:103], v[84:87]
    ds_read_b64_tr_b16 a[36:37], v229 offset:16384
    v_mfma_f32_16x16x32_bf16 v[88:91], a[164:167], a[104:107], v[88:91]
    ds_read_b64_tr_b16 a[38:39], v229 offset:18432
    v_mfma_f32_16x16x32_bf16 v[92:95], a[164:167], a[108:111], v[92:95]
    buffer_load_dwordx4 a[216:219], v238, s[80:83], s85 offen offset:1024 sc1
    s_waitcnt vmcnt(12)
    v_mfma_f32_16x16x32_bf16 v[96:99], a[168:171], a[96:99], v[96:99]
    ds_read_b64_tr_b16 a[40:41], v230 offset:16384
    v_mfma_f32_16x16x32_bf16 v[100:103], a[168:171], a[100:103], v[100:103]
    ds_read_b64_tr_b16 a[42:43], v230 offset:18432
    v_mfma_f32_16x16x32_bf16 v[104:107], a[168:171], a[104:107], v[104:107]
    buffer_load_dwordx4 a[232:235], v238, s[80:83], s86 offen offset:0 sc1
    v_mfma_f32_16x16x32_bf16 v[108:111], a[168:171], a[108:111], v[108:111]
    ds_read_b64_tr_b16 a[44:45], v231 offset:16384
    s_waitcnt vmcnt(12)
    v_mfma_f32_16x16x32_bf16 v[112:115], a[172:175], a[96:99], v[112:115]
    ds_read_b64_tr_b16 a[46:47], v231 offset:18432
    v_mfma_f32_16x16x32_bf16 v[116:119], a[172:175], a[100:103], v[116:119]
    v_mfma_f32_16x16x32_bf16 v[120:123], a[172:175], a[104:107], v[120:123]
    v_mfma_f32_16x16x32_bf16 v[124:127], a[172:175], a[108:111], v[124:127]
    s_waitcnt lgkmcnt(0)
    s_waitcnt vmcnt(11)
    v_mfma_f32_16x16x32_bf16 v[64:67], a[176:179], a[112:115], v[64:67]
    buffer_load_dwordx4 a[188:191], v239, s[80:83], s84 offen offset:3072 sc1
    v_mfma_f32_16x16x32_bf16 v[68:71], a[176:179], a[116:119], v[68:71]
    s_cmp_lt_u32 s6, 16
    s_cselect_b32 s12, 98304, 0
    v_mfma_f32_16x16x32_bf16 v[72:75], a[176:179], a[120:123], v[72:75]
    v_mul_u32_u24 v60, 144, v2
    v_mfma_f32_16x16x32_bf16 v[76:79], a[176:179], a[124:127], v[76:79]
    buffer_load_dwordx4 a[204:207], v239, s[80:83], s85 offen offset:0 sc1
    s_waitcnt vmcnt(12)
    v_mfma_f32_16x16x32_bf16 v[64:67], a[192:195], a[0:3], v[64:67]
    v_lshl_add_u32 v60, v3, 3, v60
    v_mfma_f32_16x16x32_bf16 v[68:71], a[192:195], a[4:7], v[68:71]
    s_lshl_b32 s13, s3, 5
    v_mfma_f32_16x16x32_bf16 v[72:75], a[192:195], a[8:11], v[72:75]
    v_mfma_f32_16x16x32_bf16 v[76:79], a[192:195], a[12:15], v[76:79]
    buffer_load_dwordx4 a[220:223], v239, s[80:83], s85 offen offset:1024 sc1
    s_waitcnt vmcnt(12)
    v_mfma_f32_16x16x32_bf16 v[64:67], a[208:211], a[16:19], v[64:67]
    s_add_u32 s13, s13, s12
    v_mfma_f32_16x16x32_bf16 v[68:71], a[208:211], a[20:23], v[68:71]
    v_add_u32 v60, s13, v60
    v_mfma_f32_16x16x32_bf16 v[72:75], a[208:211], a[24:27], v[72:75]
    buffer_load_dwordx4 a[236:239], v239, s[80:83], s86 offen offset:0 sc1
    v_mfma_f32_16x16x32_bf16 v[76:79], a[208:211], a[28:31], v[76:79]
    v_lshrrev_b32 v62, 3, v1
    s_waitcnt vmcnt(12)
    v_mfma_f32_16x16x32_bf16 v[64:67], a[224:227], a[32:35], v[64:67]
    v_mfma_f32_16x16x32_bf16 v[68:71], a[224:227], a[36:39], v[68:71]
    v_mfma_f32_16x16x32_bf16 v[72:75], a[224:227], a[40:43], v[72:75]
    v_mfma_f32_16x16x32_bf16 v[76:79], a[224:227], a[44:47], v[76:79]
    s_waitcnt vmcnt(11)
    v_mfma_f32_16x16x32_bf16 v[80:83], a[180:183], a[112:115], v[80:83]
    v_and_b32 v63, 7, v1
    v_mfma_f32_16x16x32_bf16 v[84:87], a[180:183], a[116:119], v[84:87]
    v_mfma_f32_16x16x32_bf16 v[88:91], a[180:183], a[120:123], v[88:91]
    v_mul_u32_u24 v61, 144, v62
    v_mfma_f32_16x16x32_bf16 v[92:95], a[180:183], a[124:127], v[92:95]
    s_waitcnt vmcnt(10)
    v_mfma_f32_16x16x32_bf16 v[80:83], a[196:199], a[0:3], v[80:83]
    v_lshl_add_u32 v61, v63, 4, v61
    v_mfma_f32_16x16x32_bf16 v[84:87], a[196:199], a[4:7], v[84:87]
    v_mfma_f32_16x16x32_bf16 v[88:91], a[196:199], a[8:11], v[88:91]
    s_mul_i32 s13, s3, 2304
    v_mfma_f32_16x16x32_bf16 v[92:95], a[196:199], a[12:15], v[92:95]
    s_waitcnt vmcnt(9)
    v_mfma_f32_16x16x32_bf16 v[80:83], a[212:215], a[16:19], v[80:83]
    ds_write_b128 v244, v[64:67] offset:0
    v_mfma_f32_16x16x32_bf16 v[84:87], a[212:215], a[20:23], v[84:87]
    s_add_u32 s13, s13, s12
    v_mfma_f32_16x16x32_bf16 v[88:91], a[212:215], a[24:27], v[88:91]
    ds_write_b128 v244, v[68:71] offset:1024
    v_mfma_f32_16x16x32_bf16 v[92:95], a[212:215], a[28:31], v[92:95]
    v_add_u32 v61, s13, v61
    s_waitcnt vmcnt(8)
    v_mfma_f32_16x16x32_bf16 v[80:83], a[228:231], a[32:35], v[80:83]
    ds_write_b128 v244, v[72:75] offset:2048
    v_mfma_f32_16x16x32_bf16 v[84:87], a[228:231], a[36:39], v[84:87]
    v_lshlrev_b32 v62, 10, v62
    v_mfma_f32_16x16x32_bf16 v[88:91], a[228:231], a[40:43], v[88:91]
    ds_write_b128 v244, v[76:79] offset:3072
    v_mfma_f32_16x16x32_bf16 v[92:95], a[228:231], a[44:47], v[92:95]
    s_waitcnt vmcnt(7)
    v_mfma_f32_16x16x32_bf16 v[96:99], a[184:187], a[112:115], v[96:99]
    v_lshl_add_u32 v62, v63, 4, v62
    v_mfma_f32_16x16x32_bf16 v[100:103], a[184:187], a[116:119], v[100:103]
    v_mfma_f32_16x16x32_bf16 v[104:107], a[184:187], a[120:123], v[104:107]
    s_lshl_b32 s12, s10, 16
    v_mfma_f32_16x16x32_bf16 v[108:111], a[184:187], a[124:127], v[108:111]
    s_waitcnt vmcnt(6)
    v_mfma_f32_16x16x32_bf16 v[96:99], a[200:203], a[0:3], v[96:99]
    s_lshl_b32 s13, s3, 14
    v_mfma_f32_16x16x32_bf16 v[100:103], a[200:203], a[4:7], v[100:103]
    v_mfma_f32_16x16x32_bf16 v[104:107], a[200:203], a[8:11], v[104:107]
    s_add_u32 s12, s12, s13
    v_mfma_f32_16x16x32_bf16 v[108:111], a[200:203], a[12:15], v[108:111]
    s_waitcnt vmcnt(5)
    v_mfma_f32_16x16x32_bf16 v[96:99], a[216:219], a[16:19], v[96:99]
    ds_write_b128 v244, v[80:83] offset:4096
    v_mfma_f32_16x16x32_bf16 v[100:103], a[216:219], a[20:23], v[100:103]
    s_lshl_b32 s13, s11, 7
    v_mfma_f32_16x16x32_bf16 v[104:107], a[216:219], a[24:27], v[104:107]
    ds_write_b128 v244, v[84:87] offset:5120
    v_mfma_f32_16x16x32_bf16 v[108:111], a[216:219], a[28:31], v[108:111]
    s_add_u32 s12, s12, s13
    s_waitcnt vmcnt(4)
    v_mfma_f32_16x16x32_bf16 v[96:99], a[232:235], a[32:35], v[96:99]
    ds_write_b128 v244, v[88:91] offset:6144
    v_mfma_f32_16x16x32_bf16 v[100:103], a[232:235], a[36:39], v[100:103]
    v_add_u32 v62, s12, v62
    v_mfma_f32_16x16x32_bf16 v[104:107], a[232:235], a[40:43], v[104:107]
    ds_write_b128 v244, v[92:95] offset:7168
    v_mfma_f32_16x16x32_bf16 v[108:111], a[232:235], a[44:47], v[108:111]
    s_waitcnt vmcnt(3)
    v_mfma_f32_16x16x32_bf16 v[112:115], a[188:191], a[112:115], v[112:115]
    v_mfma_f32_16x16x32_bf16 v[116:119], a[188:191], a[116:119], v[116:119]
    v_mfma_f32_16x16x32_bf16 v[120:123], a[188:191], a[120:123], v[120:123]
    v_mfma_f32_16x16x32_bf16 v[124:127], a[188:191], a[124:127], v[124:127]
    s_waitcnt vmcnt(2)
    v_mfma_f32_16x16x32_bf16 v[112:115], a[204:207], a[0:3], v[112:115]
    v_mfma_f32_16x16x32_bf16 v[116:119], a[204:207], a[4:7], v[116:119]
    v_mfma_f32_16x16x32_bf16 v[120:123], a[204:207], a[8:11], v[120:123]
    v_mfma_f32_16x16x32_bf16 v[124:127], a[204:207], a[12:15], v[124:127]
    s_waitcnt vmcnt(1)
    v_mfma_f32_16x16x32_bf16 v[112:115], a[220:223], a[16:19], v[112:115]
    ds_write_b128 v244, v[96:99] offset:8192
    v_mfma_f32_16x16x32_bf16 v[116:119], a[220:223], a[20:23], v[116:119]
    ds_write_b128 v244, v[100:103] offset:9216
    v_mfma_f32_16x16x32_bf16 v[120:123], a[220:223], a[24:27], v[120:123]
    v_mfma_f32_16x16x32_bf16 v[124:127], a[220:223], a[28:31], v[124:127]
    ds_write_b128 v244, v[104:107] offset:10240
    s_waitcnt vmcnt(0)
    v_mfma_f32_16x16x32_bf16 v[112:115], a[236:239], a[32:35], v[112:115]
    v_mfma_f32_16x16x32_bf16 v[116:119], a[236:239], a[36:39], v[116:119]
    ds_write_b128 v244, v[108:111] offset:11264
    v_mfma_f32_16x16x32_bf16 v[120:123], a[236:239], a[40:43], v[120:123]
    v_mfma_f32_16x16x32_bf16 v[124:127], a[236:239], a[44:47], v[124:127]
    s_waitcnt lgkmcnt(0)
    s_barrier
    ds_read_b128 v[128:131], v245 offset:0
    ds_read_b128 v[132:135], v245 offset:1024
    ds_read_b128 v[136:139], v245 offset:2048
    ds_read_b128 v[140:143], v245 offset:3072
    ds_read_b128 v[144:147], v246 offset:0
    ds_read_b128 v[148:151], v246 offset:1024
    ds_read_b128 v[152:155], v246 offset:2048
    ds_read_b128 v[156:159], v246 offset:3072
    ds_read_b128 v[160:163], v247 offset:0
    ds_read_b128 v[164:167], v247 offset:1024
    ds_read_b128 v[168:171], v247 offset:2048
    ds_read_b128 v[172:175], v247 offset:3072
    s_waitcnt lgkmcnt(8)
    v_pk_add_f32 v[112:113], v[112:113], v[128:129]
    v_pk_add_f32 v[114:115], v[114:115], v[130:131]
    v_pk_add_f32 v[116:117], v[116:117], v[132:133]
    v_pk_add_f32 v[118:119], v[118:119], v[134:135]
    v_pk_add_f32 v[120:121], v[120:121], v[136:137]
    v_pk_add_f32 v[122:123], v[122:123], v[138:139]
    v_pk_add_f32 v[124:125], v[124:125], v[140:141]
    v_pk_add_f32 v[126:127], v[126:127], v[142:143]
    s_waitcnt lgkmcnt(4)
    v_pk_add_f32 v[112:113], v[112:113], v[144:145]
    v_pk_add_f32 v[114:115], v[114:115], v[146:147]
    v_pk_add_f32 v[116:117], v[116:117], v[148:149]
    v_pk_add_f32 v[118:119], v[118:119], v[150:151]
    v_pk_add_f32 v[120:121], v[120:121], v[152:153]
    v_pk_add_f32 v[122:123], v[122:123], v[154:155]
    v_pk_add_f32 v[124:125], v[124:125], v[156:157]
    v_pk_add_f32 v[126:127], v[126:127], v[158:159]
    s_waitcnt lgkmcnt(0)
    v_pk_add_f32 v[112:113], v[112:113], v[160:161]
    v_pk_add_f32 v[114:115], v[114:115], v[162:163]
    v_pk_add_f32 v[116:117], v[116:117], v[164:165]
    v_pk_add_f32 v[118:119], v[118:119], v[166:167]
    v_pk_add_f32 v[120:121], v[120:121], v[168:169]
    v_pk_add_f32 v[122:123], v[122:123], v[170:171]
    v_pk_add_f32 v[124:125], v[124:125], v[172:173]
    v_pk_add_f32 v[126:127], v[126:127], v[174:175]
    v_pk_mul_f32 v[112:113], v[112:113], v[48:49] op_sel_hi:[1,0]
    v_pk_mul_f32 v[114:115], v[114:115], v[48:49] op_sel_hi:[1,0]
    v_pk_mul_f32 v[116:117], v[116:117], v[50:51] op_sel_hi:[1,0]
    v_pk_mul_f32 v[118:119], v[118:119], v[50:51] op_sel_hi:[1,0]
    v_pk_mul_f32 v[120:121], v[120:121], v[52:53] op_sel_hi:[1,0]
    v_pk_mul_f32 v[122:123], v[122:123], v[52:53] op_sel_hi:[1,0]
    v_pk_mul_f32 v[124:125], v[124:125], v[54:55] op_sel_hi:[1,0]
    v_pk_mul_f32 v[126:127], v[126:127], v[54:55] op_sel_hi:[1,0]
    v_cvt_pk_bf16_f32 v32, v112, v113
    v_cvt_pk_bf16_f32 v33, v114, v115
    ds_write_b64 v60, v[32:33] offset:0
    v_cvt_pk_bf16_f32 v34, v116, v117
    v_cvt_pk_bf16_f32 v35, v118, v119
    ds_write_b64 v60, v[34:35] offset:2304
    v_cvt_pk_bf16_f32 v36, v120, v121
    v_cvt_pk_bf16_f32 v37, v122, v123
    ds_write_b64 v60, v[36:37] offset:4608
    v_cvt_pk_bf16_f32 v38, v124, v125
    v_cvt_pk_bf16_f32 v39, v126, v127
    ds_write_b64 v60, v[38:39] offset:6912
    s_waitcnt lgkmcnt(0)
    s_barrier
    ds_read_b128 v[40:43], v61
    ds_read_b128 v[44:47], v61 offset:1152
    s_waitcnt lgkmcnt(1)
    buffer_store_dwordx4 v[40:43], v62, s[72:75], 0 offen sc1
    s_waitcnt lgkmcnt(0)
    buffer_store_dwordx4 v[44:47], v62, s[72:75], s85 offen sc1
L_end:
    s_endpgm
.section .rodata,"a"
.p2align 6
.amdhsa_kernel gated_mix__linear_attn_block__mixer_token_mlp__prompt_kernel
  .amdhsa_next_free_vgpr 512
  .amdhsa_next_free_sgpr 102
  .amdhsa_accum_offset 256
  .amdhsa_group_segment_fixed_size 0
  .amdhsa_kernarg_size 96
  .amdhsa_user_sgpr_count 2
  .amdhsa_user_sgpr_kernarg_segment_ptr 1
  .amdhsa_system_sgpr_workgroup_id_x 1
.end_amdhsa_kernel
```
